```python
import torch

def _softmax(x, axis=-1):
    return torch.softmax(x, dim=axis)
def _gelu(x):
    return torch.nn.functional.gelu(x, approximate="tanh")
def _silu(x):
    return torch.nn.functional.silu(x)
def _sigmoid(x):
    return torch.sigmoid(x)
def _layernorm(x, axis=-1, eps=1e-5):
    m = x.mean(dim=axis, keepdim=True)
    v = x.var(dim=axis, keepdim=True, unbiased=False)
    return (x - m) / torch.sqrt(v + eps)
def _scatter_add(tgt, idx, src, axis=0):
    return tgt.clone().index_add_(axis, idx, src)
def _segment_sum(src, seg, n):
    out = torch.zeros((n,) + src.shape[1:], dtype=src.dtype)
    return out.index_add_(0, seg, src)
def _pad(x, pw):
    flat = tuple(v for pair in reversed(pw) for v in pair)
    return torch.nn.functional.pad(x, flat)

kernel_name = 'concat_heads__sliding_block__sliding_block__prompt'

def setup_inputs():

    _w = (lambda a: (lambda t: t.to(torch.bfloat16) if t.is_floating_point() else t)(torch.as_tensor(a)))
    def _A_setup():
        B, S, D = 1, 2048, 448
        return {
            "x": _w((lambda *s: torch.randn(*s, dtype=torch.bfloat16) * 0.4)(B, S, D)),
            "wqkv": _w((lambda *s: torch.randn(*s, dtype=torch.bfloat16) * 0.4)(D, 3 * D)),
            "wo": _w((lambda *s: torch.randn(*s, dtype=torch.bfloat16) * 0.05)(D, D)),
        }
    _A_in = _A_setup()

    def _B_setup():
        B, S, D = 1, 2048, 448
        return {
            "x": _w((lambda *s: torch.randn(*s, dtype=torch.bfloat16) * 0.4)(B, S, D)),
            "wqkv": _w((lambda *s: torch.randn(*s, dtype=torch.bfloat16) * 0.4)(D, 3 * D)),
            "wo": _w((lambda *s: torch.randn(*s, dtype=torch.bfloat16) * 0.05)(D, D)),
        }
    _B_in = _B_setup()

    return {
        "A_x": _A_in["x"],
        "A_wqkv": _A_in["wqkv"],
        "A_wo": _A_in["wo"],
        "B_x": _B_in["x"],
        "B_wqkv": _B_in["wqkv"],
        "B_wo": _B_in["wo"],
    }

def reference(A_x, A_wqkv, A_wo, B_x, B_wqkv, B_wo):
    def _A_ref(x, wqkv, wo):
        B, S, D = x.shape
        H = 16; Dh = D // H; W = 256
        qkv = (lambda x, *d: x.permute(*d))((x @ wqkv).reshape(B, S, 3, H, Dh), 2, 0, 3, 1, 4)
        q, k, v = qkv[0], qkv[1], qkv[2]
        scores = torch.einsum("bhqd,bhkd->bhqk", q, k) * (Dh ** -0.5)
        idx = torch.arange(S)
        mask = (idx[:, None] - idx[None, :] >= 0) & (idx[:, None] - idx[None, :] < W)
        scores = torch.where(mask[None, None], scores, -1e9)
        p = _softmax(scores, axis=-1)
        o = torch.einsum("bhqk,bhkd->bhqd", p, v)
        return (lambda x, *d: x.permute(*d))(o, 0, 2, 1, 3).reshape(B, S, D) @ wo

    def _B_ref(x, wqkv, wo):
        B, S, D = x.shape
        H = 16; Dh = D // H; W = 256
        qkv = (lambda x, *d: x.permute(*d))((x @ wqkv).reshape(B, S, 3, H, Dh), 2, 0, 3, 1, 4)
        q, k, v = qkv[0], qkv[1], qkv[2]
        scores = torch.einsum("bhqd,bhkd->bhqk", q, k) * (Dh ** -0.5)
        idx = torch.arange(S)
        mask = (idx[:, None] - idx[None, :] >= 0) & (idx[:, None] - idx[None, :] < W)
        scores = torch.where(mask[None, None], scores, -1e9)
        p = _softmax(scores, axis=-1)
        o = torch.einsum("bhqk,bhkd->bhqd", p, v)
        return (lambda x, *d: x.permute(*d))(o, 0, 2, 1, 3).reshape(B, S, D) @ wo

    a = _A_ref(A_x, A_wqkv, A_wo)
    b = _B_ref(B_x, B_wqkv, B_wo)
    return torch.concatenate([a, b], axis=-1)
```

```asm
; @launch kernel=qkv_kernel grid=(224,1,1) block=(512,1,1) lds=122880
; @launch kernel=attn_kernel grid=(256,1,1) block=(512,1,1) lds=65536
; @launch kernel=proj_kernel grid=(224,1,1) block=(512,1,1) lds=155776
.amdgcn_target "amdgcn-amd-amdhsa--gfx950"
.text
.p2align 8
.globl qkv_kernel
.type qkv_kernel,@function
qkv_kernel:
    s_cmp_ge_u32 s2, 224
    s_cbranch_scc1 L_end_qkv_kernel
    s_load_dwordx16 s[4:19], s[0:1], 0
    s_load_dwordx2 s[20:21], s[0:1], 64
    v_lshrrev_b32 v1, 6, v0
    v_and_b32 v2, 63, v0
    v_readfirstlane_b32 s40, v1
    s_and_b32 s36, s2, 7
    s_lshr_b32 s37, s2, 3
    s_lshr_b32 s38, s36, 2
    s_and_b32 s36, s36, 3
    s_mul_i32 s39, s37, 37
    s_lshr_b32 s39, s39, 8
    s_mul_i32 s41, s39, 7
    s_sub_u32 s41, s37, s41
    s_mul_i32 s42, s36, 4
    s_add_u32 s42, s42, s39
    s_and_b32 s43, s40, 3
    v_and_b32 v3, 15, v2
    v_lshrrev_b32 v4, 4, v2
    s_cmp_ge_u32 s40, 4
    s_cbranch_scc1 L_load_qkv_kernel
    s_and_b32 s44, s43, 1
    s_lshr_b32 s45, s43, 1
    v_lshrrev_b32 v12, 1, v3
    v_xor_b32 v12, v12, v4
    v_lshlrev_b32 v12, 4, v12
    v_lshl_add_u32 v12, v3, 7, v12
    s_lshl_b32 s46, s44, 13
    s_add_u32 s46, s46, 73728
    v_add_u32 v12, s46, v12
    v_xor_b32 v13, 64, v12
    v_mul_u32_u24 v5, 3072, v4
    v_lshrrev_b32 v7, 2, v3
    v_lshl_add_u32 v5, v7, 7, v5
    v_and_b32 v8, 3, v2
    v_lshl_add_u32 v5, v8, 3, v5
    v_and_b32 v7, 2, v7
    v_and_b32 v8, 1, v4
    v_or_b32 v7, v7, v8
    s_mul_i32 s49, s45, 6
    s_add_u32 s50, s49, 0
    s_lshr_b32 s51, s50, 2
    s_and_b32 s50, s50, 3
    s_lshl_b32 s51, s51, 10
    v_xor_b32 v8, s50, v7
    v_lshlrev_b32 v8, 5, v8
    v_add3_u32 v6, v5, v8, s51
    s_add_u32 s50, s49, 1
    s_lshr_b32 s51, s50, 2
    s_and_b32 s50, s50, 3
    s_lshl_b32 s51, s51, 10
    v_xor_b32 v8, s50, v7
    v_lshlrev_b32 v8, 5, v8
    v_add3_u32 v9, v5, v8, s51
    s_add_u32 s50, s49, 2
    s_lshr_b32 s51, s50, 2
    s_and_b32 s50, s50, 3
    s_lshl_b32 s51, s51, 10
    v_xor_b32 v8, s50, v7
    v_lshlrev_b32 v8, 5, v8
    v_add3_u32 v10, v5, v8, s51
    s_add_u32 s50, s49, 3
    s_lshr_b32 s51, s50, 2
    s_and_b32 s50, s50, 3
    s_lshl_b32 s51, s51, 10
    v_xor_b32 v8, s50, v7
    v_lshlrev_b32 v8, 5, v8
    v_add3_u32 v11, v5, v8, s51
    s_add_u32 s50, s49, 4
    s_lshr_b32 s51, s50, 2
    s_and_b32 s50, s50, 3
    s_lshl_b32 s51, s51, 10
    v_xor_b32 v8, s50, v7
    v_lshlrev_b32 v8, 5, v8
    v_add3_u32 v14, v5, v8, s51
    s_add_u32 s50, s49, 5
    s_lshr_b32 s51, s50, 2
    s_and_b32 s50, s50, 3
    s_lshl_b32 s51, s51, 10
    v_xor_b32 v8, s50, v7
    v_lshlrev_b32 v8, 5, v8
    v_add3_u32 v15, v5, v8, s51
    v_lshrrev_b32 v7, 2, v2
    v_and_b32 v8, 3, v2
    s_mul_i32 s46, s43, 5
    v_add_u32 v1, s46, v7
    v_mul_u32_u24 v1, 7, v1
    s_lshl_b32 s46, s42, 7
    s_add_u32 s46, s46, s41
    v_add_u32 v1, s46, v1
    v_mul_u32_u24 v1, 896, v1
    v_lshl_add_u32 v1, v8, 7, v1
    v_add_u32 v1, 256, v1
    v_mov_b32 v219, 0x7f000000
    v_cmp_gt_u32 s[62:63], 5, v7
    v_cmp_gt_u32 s[60:61], 2, v8
    s_nop 1
    s_and_b64 vcc, s[62:63], s[60:61]
    v_cndmask_b32 v212, v219, v1, vcc
    v_cmp_gt_u32 s[60:61], 3, v8
    s_nop 1
    s_and_b64 vcc, s[62:63], s[60:61]
    v_add_u32 v1, 256, v1
    v_cndmask_b32 v213, v219, v1, vcc
    s_and_b32 s46, s42, 3
    s_mul_i32 s47, s41, 384
    s_mul_i32 s50, s46, 32
    s_mul_i32 s51, s43, 8
    s_add_u32 s50, s50, s51
    s_add_u32 s50, s50, 128
    v_add_u32 v1, s50, v7
    v_mul_u32_u24 v1, 2688, v1
    v_add_u32 v1, s47, v1
    v_lshl_add_u32 v1, v8, 7, v1
    v_cmp_gt_u32 s[62:63], 8, v7
    s_nop 1
    s_and_b64 vcc, s[62:63], s[60:61]
    v_cndmask_b32 v217, v219, v1, vcc
    s_mul_i32 s50, s46, 48
    s_mul_i32 s51, s43, 12
    s_add_u32 s50, s50, s51
    s_add_u32 s50, s50, 256
    v_add_u32 v1, s50, v7
    v_mul_u32_u24 v1, 2688, v1
    v_add_u32 v1, s47, v1
    v_lshl_add_u32 v1, v8, 7, v1
    v_cmp_gt_u32 s[62:63], 12, v7
    s_nop 1
    s_and_b64 vcc, s[62:63], s[60:61]
    v_cndmask_b32 v220, v219, v1, vcc
    s_waitcnt lgkmcnt(0)
    s_cmp_eq_u32 s38, 0
    s_cselect_b32 s52, s4, s10
    s_cselect_b32 s53, s5, s11
    s_cselect_b32 s54, s6, s12
    s_cselect_b32 s55, s7, s13
    s_mov_b32 s24, s52
    s_and_b32 s25, s53, 0xffff
    s_mov_b32 s26, 1835008
    s_mov_b32 s27, 0x00020000
    s_mov_b32 s28, s54
    s_and_b32 s29, s55, 0xffff
    s_mov_b32 s30, 1204224
    s_mov_b32 s31, 0x00020000
    s_mul_i32 s56, s38, 6291456
    s_add_u32 s52, s20, s56
    s_addc_u32 s53, s21, 0
    s_mov_b32 s32, s52
    s_and_b32 s33, s53, 0xffff
    s_mov_b32 s34, 6291456
    s_mov_b32 s35, 0x00020000
    s_lshl_b32 s58, s42, 2
    s_lshl_b32 s47, s44, 1
    s_add_u32 s58, s58, s47
    s_lshl_b32 s58, s58, 11
    s_add_u32 s59, s58, 2048
    s_mul_i32 s46, s41, 192
    s_mul_i32 s47, s45, 96
    s_add_u32 s46, s46, s47
    s_mov_b32 s55, 0x3e8b97f6
    s_mov_b32 s50, 9363
    v_lshlrev_b32 v5, 2, v4
    v_add_u32 v5, s46, v5
    v_add_u32 v1, 0, v5
    v_mul_u32_u24 v7, s50, v1
    v_lshrrev_b32 v7, 18, v7
    v_mul_u32_u24 v8, 28, v7
    v_sub_u32 v8, v1, v8
    v_lshrrev_b32 v1, 4, v7
    v_and_b32 v7, 15, v7
    v_mul_u32_u24 v7, 3, v7
    v_add_u32 v7, v7, v1
    v_lshlrev_b32 v7, 17, v7
    v_lshl_add_u32 v7, v8, 6, v7
    v_cmp_eq_u32 vcc, 2, v1
    s_nop 1
    v_cndmask_b32 v8, 0, v8, vcc
    v_xor_b32 v8, v8, v3
    v_lshl_add_u32 v192, v8, 3, v7
    v_xor_b32 v198, 128, v192
    v_cmp_eq_u32 vcc, 0, v1
    v_mov_b32 v7, 1.0
    v_mov_b32 v8, s55
    v_cndmask_b32 v204, v7, v8, vcc
    v_add_u32 v1, 16, v5
    v_mul_u32_u24 v7, s50, v1
    v_lshrrev_b32 v7, 18, v7
    v_mul_u32_u24 v8, 28, v7
    v_sub_u32 v8, v1, v8
    v_lshrrev_b32 v1, 4, v7
    v_and_b32 v7, 15, v7
    v_mul_u32_u24 v7, 3, v7
    v_add_u32 v7, v7, v1
    v_lshlrev_b32 v7, 17, v7
    v_lshl_add_u32 v7, v8, 6, v7
    v_cmp_eq_u32 vcc, 2, v1
    s_nop 1
    v_cndmask_b32 v8, 0, v8, vcc
    v_xor_b32 v8, v8, v3
    v_lshl_add_u32 v193, v8, 3, v7
    v_xor_b32 v199, 128, v193
    v_cmp_eq_u32 vcc, 0, v1
    v_mov_b32 v7, 1.0
    v_mov_b32 v8, s55
    v_cndmask_b32 v205, v7, v8, vcc
    v_add_u32 v1, 32, v5
    v_mul_u32_u24 v7, s50, v1
    v_lshrrev_b32 v7, 18, v7
    v_mul_u32_u24 v8, 28, v7
    v_sub_u32 v8, v1, v8
    v_lshrrev_b32 v1, 4, v7
    v_and_b32 v7, 15, v7
    v_mul_u32_u24 v7, 3, v7
    v_add_u32 v7, v7, v1
    v_lshlrev_b32 v7, 17, v7
    v_lshl_add_u32 v7, v8, 6, v7
    v_cmp_eq_u32 vcc, 2, v1
    s_nop 1
    v_cndmask_b32 v8, 0, v8, vcc
    v_xor_b32 v8, v8, v3
    v_lshl_add_u32 v194, v8, 3, v7
    v_xor_b32 v200, 128, v194
    v_cmp_eq_u32 vcc, 0, v1
    v_mov_b32 v7, 1.0
    v_mov_b32 v8, s55
    v_cndmask_b32 v206, v7, v8, vcc
    v_add_u32 v1, 48, v5
    v_mul_u32_u24 v7, s50, v1
    v_lshrrev_b32 v7, 18, v7
    v_mul_u32_u24 v8, 28, v7
    v_sub_u32 v8, v1, v8
    v_lshrrev_b32 v1, 4, v7
    v_and_b32 v7, 15, v7
    v_mul_u32_u24 v7, 3, v7
    v_add_u32 v7, v7, v1
    v_lshlrev_b32 v7, 17, v7
    v_lshl_add_u32 v7, v8, 6, v7
    v_cmp_eq_u32 vcc, 2, v1
    s_nop 1
    v_cndmask_b32 v8, 0, v8, vcc
    v_xor_b32 v8, v8, v3
    v_lshl_add_u32 v195, v8, 3, v7
    v_xor_b32 v201, 128, v195
    v_cmp_eq_u32 vcc, 0, v1
    v_mov_b32 v7, 1.0
    v_mov_b32 v8, s55
    v_cndmask_b32 v207, v7, v8, vcc
    v_add_u32 v1, 64, v5
    v_mul_u32_u24 v7, s50, v1
    v_lshrrev_b32 v7, 18, v7
    v_mul_u32_u24 v8, 28, v7
    v_sub_u32 v8, v1, v8
    v_lshrrev_b32 v1, 4, v7
    v_and_b32 v7, 15, v7
    v_mul_u32_u24 v7, 3, v7
    v_add_u32 v7, v7, v1
    v_lshlrev_b32 v7, 17, v7
    v_lshl_add_u32 v7, v8, 6, v7
    v_cmp_eq_u32 vcc, 2, v1
    s_nop 1
    v_cndmask_b32 v8, 0, v8, vcc
    v_xor_b32 v8, v8, v3
    v_lshl_add_u32 v196, v8, 3, v7
    v_xor_b32 v202, 128, v196
    v_cmp_eq_u32 vcc, 0, v1
    v_mov_b32 v7, 1.0
    v_mov_b32 v8, s55
    v_cndmask_b32 v208, v7, v8, vcc
    v_add_u32 v1, 80, v5
    v_mul_u32_u24 v7, s50, v1
    v_lshrrev_b32 v7, 18, v7
    v_mul_u32_u24 v8, 28, v7
    v_sub_u32 v8, v1, v8
    v_lshrrev_b32 v1, 4, v7
    v_and_b32 v7, 15, v7
    v_mul_u32_u24 v7, 3, v7
    v_add_u32 v7, v7, v1
    v_lshlrev_b32 v7, 17, v7
    v_lshl_add_u32 v7, v8, 6, v7
    v_cmp_eq_u32 vcc, 2, v1
    s_nop 1
    v_cndmask_b32 v8, 0, v8, vcc
    v_xor_b32 v8, v8, v3
    v_lshl_add_u32 v197, v8, 3, v7
    v_xor_b32 v203, 128, v197
    v_cmp_eq_u32 vcc, 0, v1
    v_mov_b32 v7, 1.0
    v_mov_b32 v8, s55
    v_cndmask_b32 v209, v7, v8, vcc
    buffer_load_dword v214, v217, s[28:31], 0 offen
    buffer_load_dword v215, v212, s[24:27], 0 offen
    s_barrier
    buffer_load_dword v218, v220, s[28:31], 0 offen
    buffer_load_dword v221, v213, s[24:27], 0 offen
    ds_read_b128 v[16:19], v12 offset:0
    ds_read_b128 v[20:23], v12 offset:2048
    ds_read_b128 v[24:27], v12 offset:4096
    ds_read_b128 v[28:31], v12 offset:6144
    ds_read_b64_tr_b16 v[48:49], v6 offset:0
    ds_read_b64_tr_b16 v[50:51], v6 offset:512
    ds_read_b64_tr_b16 v[52:53], v9 offset:0
    ds_read_b64_tr_b16 v[54:55], v9 offset:512
    ds_read_b64_tr_b16 v[56:57], v10 offset:0
    ds_read_b64_tr_b16 v[58:59], v10 offset:512
    ds_read_b64_tr_b16 v[60:61], v11 offset:0
    ds_read_b64_tr_b16 v[62:63], v11 offset:512
    ds_read_b64_tr_b16 v[64:65], v14 offset:0
    ds_read_b64_tr_b16 v[66:67], v14 offset:512
    s_waitcnt lgkmcnt(12)
    ds_read_b64_tr_b16 v[68:69], v15 offset:0
    ds_read_b64_tr_b16 v[70:71], v15 offset:512
    s_waitcnt lgkmcnt(10)
    v_mfma_f32_16x16x32_bf16 v[96:99], v[48:51], v[16:19], 0
    v_mfma_f32_16x16x32_bf16 v[100:103], v[48:51], v[20:23], 0
    ds_read_b64_tr_b16 v[72:73], v6 offset:12288
    ds_read_b64_tr_b16 v[74:75], v6 offset:12800
    v_mfma_f32_16x16x32_bf16 v[104:107], v[48:51], v[24:27], 0
    v_mfma_f32_16x16x32_bf16 v[108:111], v[48:51], v[28:31], 0
    ds_read_b128 v[32:35], v13 offset:0
    s_waitcnt lgkmcnt(11)
    v_mfma_f32_16x16x32_bf16 v[112:115], v[52:55], v[16:19], 0
    v_mfma_f32_16x16x32_bf16 v[116:119], v[52:55], v[20:23], 0
    ds_read_b64_tr_b16 v[76:77], v9 offset:12288
    ds_read_b64_tr_b16 v[78:79], v9 offset:12800
    v_mfma_f32_16x16x32_bf16 v[120:123], v[52:55], v[24:27], 0
    v_mfma_f32_16x16x32_bf16 v[124:127], v[52:55], v[28:31], 0
    ds_read_b128 v[36:39], v13 offset:2048
    s_waitcnt lgkmcnt(12)
    v_mfma_f32_16x16x32_bf16 v[128:131], v[56:59], v[16:19], 0
    v_mfma_f32_16x16x32_bf16 v[132:135], v[56:59], v[20:23], 0
    ds_read_b64_tr_b16 v[80:81], v10 offset:12288
    ds_read_b64_tr_b16 v[82:83], v10 offset:12800
    v_mfma_f32_16x16x32_bf16 v[136:139], v[56:59], v[24:27], 0
    v_mfma_f32_16x16x32_bf16 v[140:143], v[56:59], v[28:31], 0
    ds_read_b128 v[40:43], v13 offset:4096
    s_waitcnt lgkmcnt(13)
    v_mfma_f32_16x16x32_bf16 v[144:147], v[60:63], v[16:19], 0
    v_mfma_f32_16x16x32_bf16 v[148:151], v[60:63], v[20:23], 0
    ds_read_b64_tr_b16 v[84:85], v11 offset:12288
    ds_read_b64_tr_b16 v[86:87], v11 offset:12800
    v_mfma_f32_16x16x32_bf16 v[152:155], v[60:63], v[24:27], 0
    v_mfma_f32_16x16x32_bf16 v[156:159], v[60:63], v[28:31], 0
    ds_read_b128 v[44:47], v13 offset:6144
    s_waitcnt lgkmcnt(14)
    v_mfma_f32_16x16x32_bf16 v[160:163], v[64:67], v[16:19], 0
    v_mfma_f32_16x16x32_bf16 v[164:167], v[64:67], v[20:23], 0
    ds_read_b64_tr_b16 v[88:89], v14 offset:12288
    ds_read_b64_tr_b16 v[90:91], v14 offset:12800
    v_mfma_f32_16x16x32_bf16 v[168:171], v[64:67], v[24:27], 0
    v_mfma_f32_16x16x32_bf16 v[172:175], v[64:67], v[28:31], 0
    s_waitcnt lgkmcnt(14)
    v_mfma_f32_16x16x32_bf16 v[176:179], v[68:71], v[16:19], 0
    v_mfma_f32_16x16x32_bf16 v[180:183], v[68:71], v[20:23], 0
    ds_read_b64_tr_b16 v[92:93], v15 offset:12288
    ds_read_b64_tr_b16 v[94:95], v15 offset:12800
    v_mfma_f32_16x16x32_bf16 v[184:187], v[68:71], v[24:27], 0
    v_mfma_f32_16x16x32_bf16 v[188:191], v[68:71], v[28:31], 0
    s_waitcnt lgkmcnt(0)
    s_barrier
    v_mfma_f32_16x16x32_bf16 v[96:99], v[72:75], v[32:35], v[96:99]
    v_mfma_f32_16x16x32_bf16 v[100:103], v[72:75], v[36:39], v[100:103]
    ds_read_b64_tr_b16 v[48:49], v6 offset:24576
    ds_read_b64_tr_b16 v[50:51], v6 offset:25088
    v_mfma_f32_16x16x32_bf16 v[104:107], v[72:75], v[40:43], v[104:107]
    v_mfma_f32_16x16x32_bf16 v[108:111], v[72:75], v[44:47], v[108:111]
    ds_read_b128 v[16:19], v12 offset:16384
    v_mfma_f32_16x16x32_bf16 v[112:115], v[76:79], v[32:35], v[112:115]
    v_mfma_f32_16x16x32_bf16 v[116:119], v[76:79], v[36:39], v[116:119]
    ds_read_b64_tr_b16 v[52:53], v9 offset:24576
    ds_read_b64_tr_b16 v[54:55], v9 offset:25088
    v_mfma_f32_16x16x32_bf16 v[120:123], v[76:79], v[40:43], v[120:123]
    v_mfma_f32_16x16x32_bf16 v[124:127], v[76:79], v[44:47], v[124:127]
    ds_read_b128 v[20:23], v12 offset:18432
    v_mfma_f32_16x16x32_bf16 v[128:131], v[80:83], v[32:35], v[128:131]
    v_mfma_f32_16x16x32_bf16 v[132:135], v[80:83], v[36:39], v[132:135]
    ds_read_b64_tr_b16 v[56:57], v10 offset:24576
    ds_read_b64_tr_b16 v[58:59], v10 offset:25088
    v_mfma_f32_16x16x32_bf16 v[136:139], v[80:83], v[40:43], v[136:139]
    v_mfma_f32_16x16x32_bf16 v[140:143], v[80:83], v[44:47], v[140:143]
    ds_read_b128 v[24:27], v12 offset:20480
    v_mfma_f32_16x16x32_bf16 v[144:147], v[84:87], v[32:35], v[144:147]
    v_mfma_f32_16x16x32_bf16 v[148:151], v[84:87], v[36:39], v[148:151]
    ds_read_b64_tr_b16 v[60:61], v11 offset:24576
    ds_read_b64_tr_b16 v[62:63], v11 offset:25088
    v_mfma_f32_16x16x32_bf16 v[152:155], v[84:87], v[40:43], v[152:155]
    v_mfma_f32_16x16x32_bf16 v[156:159], v[84:87], v[44:47], v[156:159]
    ds_read_b128 v[28:31], v12 offset:22528
    v_mfma_f32_16x16x32_bf16 v[160:163], v[88:91], v[32:35], v[160:163]
    v_mfma_f32_16x16x32_bf16 v[164:167], v[88:91], v[36:39], v[164:167]
    ds_read_b64_tr_b16 v[64:65], v14 offset:24576
    ds_read_b64_tr_b16 v[66:67], v14 offset:25088
    v_mfma_f32_16x16x32_bf16 v[168:171], v[88:91], v[40:43], v[168:171]
    v_mfma_f32_16x16x32_bf16 v[172:175], v[88:91], v[44:47], v[172:175]
    v_mfma_f32_16x16x32_bf16 v[176:179], v[92:95], v[32:35], v[176:179]
    v_mfma_f32_16x16x32_bf16 v[180:183], v[92:95], v[36:39], v[180:183]
    ds_read_b64_tr_b16 v[68:69], v15 offset:24576
    ds_read_b64_tr_b16 v[70:71], v15 offset:25088
    v_mfma_f32_16x16x32_bf16 v[184:187], v[92:95], v[40:43], v[184:187]
    v_mfma_f32_16x16x32_bf16 v[188:191], v[92:95], v[44:47], v[188:191]
    s_waitcnt lgkmcnt(14)
    s_waitcnt lgkmcnt(4)
    v_mfma_f32_16x16x32_bf16 v[96:99], v[48:51], v[16:19], v[96:99]
    v_mfma_f32_16x16x32_bf16 v[100:103], v[48:51], v[20:23], v[100:103]
    ds_read_b64_tr_b16 v[72:73], v6 offset:36864
    ds_read_b64_tr_b16 v[74:75], v6 offset:37376
    v_mfma_f32_16x16x32_bf16 v[104:107], v[48:51], v[24:27], v[104:107]
    v_mfma_f32_16x16x32_bf16 v[108:111], v[48:51], v[28:31], v[108:111]
    ds_read_b128 v[32:35], v13 offset:16384
    v_mfma_f32_16x16x32_bf16 v[112:115], v[52:55], v[16:19], v[112:115]
    v_mfma_f32_16x16x32_bf16 v[116:119], v[52:55], v[20:23], v[116:119]
    ds_read_b64_tr_b16 v[76:77], v9 offset:36864
    ds_read_b64_tr_b16 v[78:79], v9 offset:37376
    v_mfma_f32_16x16x32_bf16 v[120:123], v[52:55], v[24:27], v[120:123]
    v_mfma_f32_16x16x32_bf16 v[124:127], v[52:55], v[28:31], v[124:127]
    ds_read_b128 v[36:39], v13 offset:18432
    v_mfma_f32_16x16x32_bf16 v[128:131], v[56:59], v[16:19], v[128:131]
    v_mfma_f32_16x16x32_bf16 v[132:135], v[56:59], v[20:23], v[132:135]
    ds_read_b64_tr_b16 v[80:81], v10 offset:36864
    ds_read_b64_tr_b16 v[82:83], v10 offset:37376
    v_mfma_f32_16x16x32_bf16 v[136:139], v[56:59], v[24:27], v[136:139]
    v_mfma_f32_16x16x32_bf16 v[140:143], v[56:59], v[28:31], v[140:143]
    ds_read_b128 v[40:43], v13 offset:20480
    v_mfma_f32_16x16x32_bf16 v[144:147], v[60:63], v[16:19], v[144:147]
    v_mfma_f32_16x16x32_bf16 v[148:151], v[60:63], v[20:23], v[148:151]
    ds_read_b64_tr_b16 v[84:85], v11 offset:36864
    ds_read_b64_tr_b16 v[86:87], v11 offset:37376
    v_mfma_f32_16x16x32_bf16 v[152:155], v[60:63], v[24:27], v[152:155]
    v_mfma_f32_16x16x32_bf16 v[156:159], v[60:63], v[28:31], v[156:159]
    ds_read_b128 v[44:47], v13 offset:22528
    s_waitcnt lgkmcnt(14)
    v_mfma_f32_16x16x32_bf16 v[160:163], v[64:67], v[16:19], v[160:163]
    v_mfma_f32_16x16x32_bf16 v[164:167], v[64:67], v[20:23], v[164:167]
    ds_read_b64_tr_b16 v[88:89], v14 offset:36864
    ds_read_b64_tr_b16 v[90:91], v14 offset:37376
    v_mfma_f32_16x16x32_bf16 v[168:171], v[64:67], v[24:27], v[168:171]
    v_mfma_f32_16x16x32_bf16 v[172:175], v[64:67], v[28:31], v[172:175]
    s_waitcnt lgkmcnt(14)
    v_mfma_f32_16x16x32_bf16 v[176:179], v[68:71], v[16:19], v[176:179]
    v_mfma_f32_16x16x32_bf16 v[180:183], v[68:71], v[20:23], v[180:183]
    ds_read_b64_tr_b16 v[92:93], v15 offset:36864
    ds_read_b64_tr_b16 v[94:95], v15 offset:37376
    v_mfma_f32_16x16x32_bf16 v[184:187], v[68:71], v[24:27], v[184:187]
    v_mfma_f32_16x16x32_bf16 v[188:191], v[68:71], v[28:31], v[188:191]
    s_waitcnt lgkmcnt(0)
    s_barrier
    v_mfma_f32_16x16x32_bf16 v[96:99], v[72:75], v[32:35], v[96:99]
    v_mfma_f32_16x16x32_bf16 v[100:103], v[72:75], v[36:39], v[100:103]
    ds_read_b64_tr_b16 v[48:49], v6 offset:49152
    ds_read_b64_tr_b16 v[50:51], v6 offset:49664
    v_mfma_f32_16x16x32_bf16 v[104:107], v[72:75], v[40:43], v[104:107]
    v_mfma_f32_16x16x32_bf16 v[108:111], v[72:75], v[44:47], v[108:111]
    ds_read_b128 v[16:19], v12 offset:32768
    v_mfma_f32_16x16x32_bf16 v[112:115], v[76:79], v[32:35], v[112:115]
    v_mfma_f32_16x16x32_bf16 v[116:119], v[76:79], v[36:39], v[116:119]
    ds_read_b64_tr_b16 v[52:53], v9 offset:49152
    ds_read_b64_tr_b16 v[54:55], v9 offset:49664
    v_mfma_f32_16x16x32_bf16 v[120:123], v[76:79], v[40:43], v[120:123]
    v_mfma_f32_16x16x32_bf16 v[124:127], v[76:79], v[44:47], v[124:127]
    ds_read_b128 v[20:23], v12 offset:34816
    v_mfma_f32_16x16x32_bf16 v[128:131], v[80:83], v[32:35], v[128:131]
    v_mfma_f32_16x16x32_bf16 v[132:135], v[80:83], v[36:39], v[132:135]
    ds_read_b64_tr_b16 v[56:57], v10 offset:49152
    ds_read_b64_tr_b16 v[58:59], v10 offset:49664
    v_mfma_f32_16x16x32_bf16 v[136:139], v[80:83], v[40:43], v[136:139]
    v_mfma_f32_16x16x32_bf16 v[140:143], v[80:83], v[44:47], v[140:143]
    ds_read_b128 v[24:27], v12 offset:36864
    v_mfma_f32_16x16x32_bf16 v[144:147], v[84:87], v[32:35], v[144:147]
    v_mfma_f32_16x16x32_bf16 v[148:151], v[84:87], v[36:39], v[148:151]
    ds_read_b64_tr_b16 v[60:61], v11 offset:49152
    ds_read_b64_tr_b16 v[62:63], v11 offset:49664
    v_mfma_f32_16x16x32_bf16 v[152:155], v[84:87], v[40:43], v[152:155]
    v_mfma_f32_16x16x32_bf16 v[156:159], v[84:87], v[44:47], v[156:159]
    ds_read_b128 v[28:31], v12 offset:38912
    v_mfma_f32_16x16x32_bf16 v[160:163], v[88:91], v[32:35], v[160:163]
    v_mfma_f32_16x16x32_bf16 v[164:167], v[88:91], v[36:39], v[164:167]
    ds_read_b64_tr_b16 v[64:65], v14 offset:49152
    ds_read_b64_tr_b16 v[66:67], v14 offset:49664
    v_mfma_f32_16x16x32_bf16 v[168:171], v[88:91], v[40:43], v[168:171]
    v_mfma_f32_16x16x32_bf16 v[172:175], v[88:91], v[44:47], v[172:175]
    v_mfma_f32_16x16x32_bf16 v[176:179], v[92:95], v[32:35], v[176:179]
    v_mfma_f32_16x16x32_bf16 v[180:183], v[92:95], v[36:39], v[180:183]
    ds_read_b64_tr_b16 v[68:69], v15 offset:49152
    ds_read_b64_tr_b16 v[70:71], v15 offset:49664
    v_mfma_f32_16x16x32_bf16 v[184:187], v[92:95], v[40:43], v[184:187]
    v_mfma_f32_16x16x32_bf16 v[188:191], v[92:95], v[44:47], v[188:191]
    s_waitcnt lgkmcnt(14)
    s_waitcnt lgkmcnt(4)
    v_mfma_f32_16x16x32_bf16 v[96:99], v[48:51], v[16:19], v[96:99]
    v_mfma_f32_16x16x32_bf16 v[100:103], v[48:51], v[20:23], v[100:103]
    ds_read_b64_tr_b16 v[72:73], v6 offset:61440
    ds_read_b64_tr_b16 v[74:75], v6 offset:61952
    v_mfma_f32_16x16x32_bf16 v[104:107], v[48:51], v[24:27], v[104:107]
    v_mfma_f32_16x16x32_bf16 v[108:111], v[48:51], v[28:31], v[108:111]
    ds_read_b128 v[32:35], v13 offset:32768
    v_mfma_f32_16x16x32_bf16 v[112:115], v[52:55], v[16:19], v[112:115]
    v_mfma_f32_16x16x32_bf16 v[116:119], v[52:55], v[20:23], v[116:119]
    ds_read_b64_tr_b16 v[76:77], v9 offset:61440
    ds_read_b64_tr_b16 v[78:79], v9 offset:61952
    v_mfma_f32_16x16x32_bf16 v[120:123], v[52:55], v[24:27], v[120:123]
    v_mfma_f32_16x16x32_bf16 v[124:127], v[52:55], v[28:31], v[124:127]
    ds_read_b128 v[36:39], v13 offset:34816
    v_mfma_f32_16x16x32_bf16 v[128:131], v[56:59], v[16:19], v[128:131]
    v_mfma_f32_16x16x32_bf16 v[132:135], v[56:59], v[20:23], v[132:135]
    ds_read_b64_tr_b16 v[80:81], v10 offset:61440
    ds_read_b64_tr_b16 v[82:83], v10 offset:61952
    v_mfma_f32_16x16x32_bf16 v[136:139], v[56:59], v[24:27], v[136:139]
    v_mfma_f32_16x16x32_bf16 v[140:143], v[56:59], v[28:31], v[140:143]
    ds_read_b128 v[40:43], v13 offset:36864
    v_mfma_f32_16x16x32_bf16 v[144:147], v[60:63], v[16:19], v[144:147]
    v_mfma_f32_16x16x32_bf16 v[148:151], v[60:63], v[20:23], v[148:151]
    ds_read_b64_tr_b16 v[84:85], v11 offset:61440
    ds_read_b64_tr_b16 v[86:87], v11 offset:61952
    v_mfma_f32_16x16x32_bf16 v[152:155], v[60:63], v[24:27], v[152:155]
    v_mfma_f32_16x16x32_bf16 v[156:159], v[60:63], v[28:31], v[156:159]
    ds_read_b128 v[44:47], v13 offset:38912
    s_waitcnt lgkmcnt(14)
    v_mfma_f32_16x16x32_bf16 v[160:163], v[64:67], v[16:19], v[160:163]
    v_mfma_f32_16x16x32_bf16 v[164:167], v[64:67], v[20:23], v[164:167]
    ds_read_b64_tr_b16 v[88:89], v14 offset:61440
    ds_read_b64_tr_b16 v[90:91], v14 offset:61952
    v_mfma_f32_16x16x32_bf16 v[168:171], v[64:67], v[24:27], v[168:171]
    v_mfma_f32_16x16x32_bf16 v[172:175], v[64:67], v[28:31], v[172:175]
    s_waitcnt lgkmcnt(14)
    v_mfma_f32_16x16x32_bf16 v[176:179], v[68:71], v[16:19], v[176:179]
    v_mfma_f32_16x16x32_bf16 v[180:183], v[68:71], v[20:23], v[180:183]
    ds_read_b64_tr_b16 v[92:93], v15 offset:61440
    ds_read_b64_tr_b16 v[94:95], v15 offset:61952
    v_mfma_f32_16x16x32_bf16 v[184:187], v[68:71], v[24:27], v[184:187]
    v_mfma_f32_16x16x32_bf16 v[188:191], v[68:71], v[28:31], v[188:191]
    s_waitcnt lgkmcnt(0)
    s_barrier
    v_mfma_f32_16x16x32_bf16 v[96:99], v[72:75], v[32:35], v[96:99]
    v_mfma_f32_16x16x32_bf16 v[100:103], v[72:75], v[36:39], v[100:103]
    ds_read_b64_tr_b16 v[48:49], v6 offset:0
    ds_read_b64_tr_b16 v[50:51], v6 offset:512
    v_mfma_f32_16x16x32_bf16 v[104:107], v[72:75], v[40:43], v[104:107]
    v_mfma_f32_16x16x32_bf16 v[108:111], v[72:75], v[44:47], v[108:111]
    ds_read_b128 v[16:19], v12 offset:0
    v_mfma_f32_16x16x32_bf16 v[112:115], v[76:79], v[32:35], v[112:115]
    v_mfma_f32_16x16x32_bf16 v[116:119], v[76:79], v[36:39], v[116:119]
    ds_read_b64_tr_b16 v[52:53], v9 offset:0
    ds_read_b64_tr_b16 v[54:55], v9 offset:512
    v_mfma_f32_16x16x32_bf16 v[120:123], v[76:79], v[40:43], v[120:123]
    v_mfma_f32_16x16x32_bf16 v[124:127], v[76:79], v[44:47], v[124:127]
    ds_read_b128 v[20:23], v12 offset:2048
    v_mfma_f32_16x16x32_bf16 v[128:131], v[80:83], v[32:35], v[128:131]
    v_mfma_f32_16x16x32_bf16 v[132:135], v[80:83], v[36:39], v[132:135]
    ds_read_b64_tr_b16 v[56:57], v10 offset:0
    ds_read_b64_tr_b16 v[58:59], v10 offset:512
    v_mfma_f32_16x16x32_bf16 v[136:139], v[80:83], v[40:43], v[136:139]
    v_mfma_f32_16x16x32_bf16 v[140:143], v[80:83], v[44:47], v[140:143]
    ds_read_b128 v[24:27], v12 offset:4096
    v_mfma_f32_16x16x32_bf16 v[144:147], v[84:87], v[32:35], v[144:147]
    v_mfma_f32_16x16x32_bf16 v[148:151], v[84:87], v[36:39], v[148:151]
    ds_read_b64_tr_b16 v[60:61], v11 offset:0
    ds_read_b64_tr_b16 v[62:63], v11 offset:512
    v_mfma_f32_16x16x32_bf16 v[152:155], v[84:87], v[40:43], v[152:155]
    v_mfma_f32_16x16x32_bf16 v[156:159], v[84:87], v[44:47], v[156:159]
    ds_read_b128 v[28:31], v12 offset:6144
    v_mfma_f32_16x16x32_bf16 v[160:163], v[88:91], v[32:35], v[160:163]
    v_mfma_f32_16x16x32_bf16 v[164:167], v[88:91], v[36:39], v[164:167]
    ds_read_b64_tr_b16 v[64:65], v14 offset:0
    ds_read_b64_tr_b16 v[66:67], v14 offset:512
    v_mfma_f32_16x16x32_bf16 v[168:171], v[88:91], v[40:43], v[168:171]
    v_mfma_f32_16x16x32_bf16 v[172:175], v[88:91], v[44:47], v[172:175]
    v_mfma_f32_16x16x32_bf16 v[176:179], v[92:95], v[32:35], v[176:179]
    v_mfma_f32_16x16x32_bf16 v[180:183], v[92:95], v[36:39], v[180:183]
    ds_read_b64_tr_b16 v[68:69], v15 offset:0
    ds_read_b64_tr_b16 v[70:71], v15 offset:512
    v_mfma_f32_16x16x32_bf16 v[184:187], v[92:95], v[40:43], v[184:187]
    v_mfma_f32_16x16x32_bf16 v[188:191], v[92:95], v[44:47], v[188:191]
    s_waitcnt lgkmcnt(14)
    s_waitcnt lgkmcnt(4)
    v_mfma_f32_16x16x32_bf16 v[96:99], v[48:51], v[16:19], v[96:99]
    v_mfma_f32_16x16x32_bf16 v[100:103], v[48:51], v[20:23], v[100:103]
    ds_read_b64_tr_b16 v[72:73], v6 offset:12288
    ds_read_b64_tr_b16 v[74:75], v6 offset:12800
    v_mfma_f32_16x16x32_bf16 v[104:107], v[48:51], v[24:27], v[104:107]
    v_mfma_f32_16x16x32_bf16 v[108:111], v[48:51], v[28:31], v[108:111]
    ds_read_b128 v[32:35], v13 offset:0
    v_mfma_f32_16x16x32_bf16 v[112:115], v[52:55], v[16:19], v[112:115]
    v_mfma_f32_16x16x32_bf16 v[116:119], v[52:55], v[20:23], v[116:119]
    ds_read_b64_tr_b16 v[76:77], v9 offset:12288
    ds_read_b64_tr_b16 v[78:79], v9 offset:12800
    v_mfma_f32_16x16x32_bf16 v[120:123], v[52:55], v[24:27], v[120:123]
    v_mfma_f32_16x16x32_bf16 v[124:127], v[52:55], v[28:31], v[124:127]
    ds_read_b128 v[36:39], v13 offset:2048
    v_mfma_f32_16x16x32_bf16 v[128:131], v[56:59], v[16:19], v[128:131]
    v_mfma_f32_16x16x32_bf16 v[132:135], v[56:59], v[20:23], v[132:135]
    ds_read_b64_tr_b16 v[80:81], v10 offset:12288
    ds_read_b64_tr_b16 v[82:83], v10 offset:12800
    v_mfma_f32_16x16x32_bf16 v[136:139], v[56:59], v[24:27], v[136:139]
    v_mfma_f32_16x16x32_bf16 v[140:143], v[56:59], v[28:31], v[140:143]
    ds_read_b128 v[40:43], v13 offset:4096
    v_mfma_f32_16x16x32_bf16 v[144:147], v[60:63], v[16:19], v[144:147]
    v_mfma_f32_16x16x32_bf16 v[148:151], v[60:63], v[20:23], v[148:151]
    ds_read_b64_tr_b16 v[84:85], v11 offset:12288
    ds_read_b64_tr_b16 v[86:87], v11 offset:12800
    v_mfma_f32_16x16x32_bf16 v[152:155], v[60:63], v[24:27], v[152:155]
    v_mfma_f32_16x16x32_bf16 v[156:159], v[60:63], v[28:31], v[156:159]
    ds_read_b128 v[44:47], v13 offset:6144
    s_waitcnt lgkmcnt(14)
    v_mfma_f32_16x16x32_bf16 v[160:163], v[64:67], v[16:19], v[160:163]
    v_mfma_f32_16x16x32_bf16 v[164:167], v[64:67], v[20:23], v[164:167]
    ds_read_b64_tr_b16 v[88:89], v14 offset:12288
    ds_read_b64_tr_b16 v[90:91], v14 offset:12800
    v_mfma_f32_16x16x32_bf16 v[168:171], v[64:67], v[24:27], v[168:171]
    v_mfma_f32_16x16x32_bf16 v[172:175], v[64:67], v[28:31], v[172:175]
    s_waitcnt lgkmcnt(14)
    v_mfma_f32_16x16x32_bf16 v[176:179], v[68:71], v[16:19], v[176:179]
    v_mfma_f32_16x16x32_bf16 v[180:183], v[68:71], v[20:23], v[180:183]
    ds_read_b64_tr_b16 v[92:93], v15 offset:12288
    ds_read_b64_tr_b16 v[94:95], v15 offset:12800
    v_mfma_f32_16x16x32_bf16 v[184:187], v[68:71], v[24:27], v[184:187]
    v_mfma_f32_16x16x32_bf16 v[188:191], v[68:71], v[28:31], v[188:191]
    s_waitcnt lgkmcnt(0)
    s_barrier
    v_mfma_f32_16x16x32_bf16 v[96:99], v[72:75], v[32:35], v[96:99]
    v_mfma_f32_16x16x32_bf16 v[100:103], v[72:75], v[36:39], v[100:103]
    ds_read_b64_tr_b16 v[48:49], v6 offset:24576
    ds_read_b64_tr_b16 v[50:51], v6 offset:25088
    v_mfma_f32_16x16x32_bf16 v[104:107], v[72:75], v[40:43], v[104:107]
    v_mfma_f32_16x16x32_bf16 v[108:111], v[72:75], v[44:47], v[108:111]
    ds_read_b128 v[16:19], v12 offset:16384
    v_mfma_f32_16x16x32_bf16 v[112:115], v[76:79], v[32:35], v[112:115]
    v_mfma_f32_16x16x32_bf16 v[116:119], v[76:79], v[36:39], v[116:119]
    ds_read_b64_tr_b16 v[52:53], v9 offset:24576
    ds_read_b64_tr_b16 v[54:55], v9 offset:25088
    v_mfma_f32_16x16x32_bf16 v[120:123], v[76:79], v[40:43], v[120:123]
    v_mfma_f32_16x16x32_bf16 v[124:127], v[76:79], v[44:47], v[124:127]
    ds_read_b128 v[20:23], v12 offset:18432
    v_mfma_f32_16x16x32_bf16 v[128:131], v[80:83], v[32:35], v[128:131]
    v_mfma_f32_16x16x32_bf16 v[132:135], v[80:83], v[36:39], v[132:135]
    ds_read_b64_tr_b16 v[56:57], v10 offset:24576
    ds_read_b64_tr_b16 v[58:59], v10 offset:25088
    v_mfma_f32_16x16x32_bf16 v[136:139], v[80:83], v[40:43], v[136:139]
    v_mfma_f32_16x16x32_bf16 v[140:143], v[80:83], v[44:47], v[140:143]
    ds_read_b128 v[24:27], v12 offset:20480
    v_mfma_f32_16x16x32_bf16 v[144:147], v[84:87], v[32:35], v[144:147]
    v_mfma_f32_16x16x32_bf16 v[148:151], v[84:87], v[36:39], v[148:151]
    ds_read_b64_tr_b16 v[60:61], v11 offset:24576
    ds_read_b64_tr_b16 v[62:63], v11 offset:25088
    v_mfma_f32_16x16x32_bf16 v[152:155], v[84:87], v[40:43], v[152:155]
    v_mfma_f32_16x16x32_bf16 v[156:159], v[84:87], v[44:47], v[156:159]
    ds_read_b128 v[28:31], v12 offset:22528
    v_mfma_f32_16x16x32_bf16 v[160:163], v[88:91], v[32:35], v[160:163]
    v_mfma_f32_16x16x32_bf16 v[164:167], v[88:91], v[36:39], v[164:167]
    ds_read_b64_tr_b16 v[64:65], v14 offset:24576
    ds_read_b64_tr_b16 v[66:67], v14 offset:25088
    v_mfma_f32_16x16x32_bf16 v[168:171], v[88:91], v[40:43], v[168:171]
    v_mfma_f32_16x16x32_bf16 v[172:175], v[88:91], v[44:47], v[172:175]
    v_mfma_f32_16x16x32_bf16 v[176:179], v[92:95], v[32:35], v[176:179]
    v_mfma_f32_16x16x32_bf16 v[180:183], v[92:95], v[36:39], v[180:183]
    ds_read_b64_tr_b16 v[68:69], v15 offset:24576
    ds_read_b64_tr_b16 v[70:71], v15 offset:25088
    v_mfma_f32_16x16x32_bf16 v[184:187], v[92:95], v[40:43], v[184:187]
    v_mfma_f32_16x16x32_bf16 v[188:191], v[92:95], v[44:47], v[188:191]
    s_waitcnt lgkmcnt(14)
    s_waitcnt lgkmcnt(4)
    v_mfma_f32_16x16x32_bf16 v[96:99], v[48:51], v[16:19], v[96:99]
    v_mfma_f32_16x16x32_bf16 v[100:103], v[48:51], v[20:23], v[100:103]
    ds_read_b64_tr_b16 v[72:73], v6 offset:36864
    ds_read_b64_tr_b16 v[74:75], v6 offset:37376
    v_mfma_f32_16x16x32_bf16 v[104:107], v[48:51], v[24:27], v[104:107]
    v_mfma_f32_16x16x32_bf16 v[108:111], v[48:51], v[28:31], v[108:111]
    ds_read_b128 v[32:35], v13 offset:16384
    v_mfma_f32_16x16x32_bf16 v[112:115], v[52:55], v[16:19], v[112:115]
    v_mfma_f32_16x16x32_bf16 v[116:119], v[52:55], v[20:23], v[116:119]
    ds_read_b64_tr_b16 v[76:77], v9 offset:36864
    ds_read_b64_tr_b16 v[78:79], v9 offset:37376
    v_mfma_f32_16x16x32_bf16 v[120:123], v[52:55], v[24:27], v[120:123]
    v_mfma_f32_16x16x32_bf16 v[124:127], v[52:55], v[28:31], v[124:127]
    ds_read_b128 v[36:39], v13 offset:18432
    v_mfma_f32_16x16x32_bf16 v[128:131], v[56:59], v[16:19], v[128:131]
    v_mfma_f32_16x16x32_bf16 v[132:135], v[56:59], v[20:23], v[132:135]
    ds_read_b64_tr_b16 v[80:81], v10 offset:36864
    ds_read_b64_tr_b16 v[82:83], v10 offset:37376
    v_mfma_f32_16x16x32_bf16 v[136:139], v[56:59], v[24:27], v[136:139]
    v_mfma_f32_16x16x32_bf16 v[140:143], v[56:59], v[28:31], v[140:143]
    ds_read_b128 v[40:43], v13 offset:20480
    v_mfma_f32_16x16x32_bf16 v[144:147], v[60:63], v[16:19], v[144:147]
    v_mfma_f32_16x16x32_bf16 v[148:151], v[60:63], v[20:23], v[148:151]
    ds_read_b64_tr_b16 v[84:85], v11 offset:36864
    ds_read_b64_tr_b16 v[86:87], v11 offset:37376
    v_mfma_f32_16x16x32_bf16 v[152:155], v[60:63], v[24:27], v[152:155]
    v_mfma_f32_16x16x32_bf16 v[156:159], v[60:63], v[28:31], v[156:159]
    ds_read_b128 v[44:47], v13 offset:22528
    s_waitcnt lgkmcnt(14)
    v_mfma_f32_16x16x32_bf16 v[160:163], v[64:67], v[16:19], v[160:163]
    v_mfma_f32_16x16x32_bf16 v[164:167], v[64:67], v[20:23], v[164:167]
    ds_read_b64_tr_b16 v[88:89], v14 offset:36864
    ds_read_b64_tr_b16 v[90:91], v14 offset:37376
    v_mfma_f32_16x16x32_bf16 v[168:171], v[64:67], v[24:27], v[168:171]
    v_mfma_f32_16x16x32_bf16 v[172:175], v[64:67], v[28:31], v[172:175]
    s_waitcnt lgkmcnt(14)
    v_mfma_f32_16x16x32_bf16 v[176:179], v[68:71], v[16:19], v[176:179]
    v_mfma_f32_16x16x32_bf16 v[180:183], v[68:71], v[20:23], v[180:183]
    ds_read_b64_tr_b16 v[92:93], v15 offset:36864
    ds_read_b64_tr_b16 v[94:95], v15 offset:37376
    v_mfma_f32_16x16x32_bf16 v[184:187], v[68:71], v[24:27], v[184:187]
    v_mfma_f32_16x16x32_bf16 v[188:191], v[68:71], v[28:31], v[188:191]
    s_waitcnt lgkmcnt(0)
    s_barrier
    v_mfma_f32_16x16x32_bf16 v[96:99], v[72:75], v[32:35], v[96:99]
    v_mfma_f32_16x16x32_bf16 v[100:103], v[72:75], v[36:39], v[100:103]
    ds_read_b64_tr_b16 v[48:49], v6 offset:49152
    ds_read_b64_tr_b16 v[50:51], v6 offset:49664
    v_mfma_f32_16x16x32_bf16 v[104:107], v[72:75], v[40:43], v[104:107]
    v_mfma_f32_16x16x32_bf16 v[108:111], v[72:75], v[44:47], v[108:111]
    ds_read_b128 v[16:19], v12 offset:32768
    v_mfma_f32_16x16x32_bf16 v[112:115], v[76:79], v[32:35], v[112:115]
    v_mfma_f32_16x16x32_bf16 v[116:119], v[76:79], v[36:39], v[116:119]
    ds_read_b64_tr_b16 v[52:53], v9 offset:49152
    ds_read_b64_tr_b16 v[54:55], v9 offset:49664
    v_mfma_f32_16x16x32_bf16 v[120:123], v[76:79], v[40:43], v[120:123]
    v_mfma_f32_16x16x32_bf16 v[124:127], v[76:79], v[44:47], v[124:127]
    ds_read_b128 v[20:23], v12 offset:34816
    v_mfma_f32_16x16x32_bf16 v[128:131], v[80:83], v[32:35], v[128:131]
    v_mfma_f32_16x16x32_bf16 v[132:135], v[80:83], v[36:39], v[132:135]
    ds_read_b64_tr_b16 v[56:57], v10 offset:49152
    ds_read_b64_tr_b16 v[58:59], v10 offset:49664
    v_mfma_f32_16x16x32_bf16 v[136:139], v[80:83], v[40:43], v[136:139]
    v_mfma_f32_16x16x32_bf16 v[140:143], v[80:83], v[44:47], v[140:143]
    ds_read_b128 v[24:27], v12 offset:36864
    v_mfma_f32_16x16x32_bf16 v[144:147], v[84:87], v[32:35], v[144:147]
    v_mfma_f32_16x16x32_bf16 v[148:151], v[84:87], v[36:39], v[148:151]
    ds_read_b64_tr_b16 v[60:61], v11 offset:49152
    ds_read_b64_tr_b16 v[62:63], v11 offset:49664
    v_mfma_f32_16x16x32_bf16 v[152:155], v[84:87], v[40:43], v[152:155]
    v_mfma_f32_16x16x32_bf16 v[156:159], v[84:87], v[44:47], v[156:159]
    ds_read_b128 v[28:31], v12 offset:38912
    v_mfma_f32_16x16x32_bf16 v[160:163], v[88:91], v[32:35], v[160:163]
    v_mfma_f32_16x16x32_bf16 v[164:167], v[88:91], v[36:39], v[164:167]
    ds_read_b64_tr_b16 v[64:65], v14 offset:49152
    ds_read_b64_tr_b16 v[66:67], v14 offset:49664
    v_mfma_f32_16x16x32_bf16 v[168:171], v[88:91], v[40:43], v[168:171]
    v_mfma_f32_16x16x32_bf16 v[172:175], v[88:91], v[44:47], v[172:175]
    v_mfma_f32_16x16x32_bf16 v[176:179], v[92:95], v[32:35], v[176:179]
    v_mfma_f32_16x16x32_bf16 v[180:183], v[92:95], v[36:39], v[180:183]
    ds_read_b64_tr_b16 v[68:69], v15 offset:49152
    ds_read_b64_tr_b16 v[70:71], v15 offset:49664
    v_mfma_f32_16x16x32_bf16 v[184:187], v[92:95], v[40:43], v[184:187]
    v_mfma_f32_16x16x32_bf16 v[188:191], v[92:95], v[44:47], v[188:191]
    s_waitcnt lgkmcnt(14)
    s_waitcnt lgkmcnt(4)
    v_mfma_f32_16x16x32_bf16 v[96:99], v[48:51], v[16:19], v[96:99]
    v_mfma_f32_16x16x32_bf16 v[100:103], v[48:51], v[20:23], v[100:103]
    ds_read_b64_tr_b16 v[72:73], v6 offset:61440
    ds_read_b64_tr_b16 v[74:75], v6 offset:61952
    v_mfma_f32_16x16x32_bf16 v[104:107], v[48:51], v[24:27], v[104:107]
    v_mfma_f32_16x16x32_bf16 v[108:111], v[48:51], v[28:31], v[108:111]
    ds_read_b128 v[32:35], v13 offset:32768
    v_mfma_f32_16x16x32_bf16 v[112:115], v[52:55], v[16:19], v[112:115]
    v_mfma_f32_16x16x32_bf16 v[116:119], v[52:55], v[20:23], v[116:119]
    ds_read_b64_tr_b16 v[76:77], v9 offset:61440
    ds_read_b64_tr_b16 v[78:79], v9 offset:61952
    v_mfma_f32_16x16x32_bf16 v[120:123], v[52:55], v[24:27], v[120:123]
    v_mfma_f32_16x16x32_bf16 v[124:127], v[52:55], v[28:31], v[124:127]
    ds_read_b128 v[36:39], v13 offset:34816
    v_mfma_f32_16x16x32_bf16 v[128:131], v[56:59], v[16:19], v[128:131]
    v_mfma_f32_16x16x32_bf16 v[132:135], v[56:59], v[20:23], v[132:135]
    ds_read_b64_tr_b16 v[80:81], v10 offset:61440
    ds_read_b64_tr_b16 v[82:83], v10 offset:61952
    v_mfma_f32_16x16x32_bf16 v[136:139], v[56:59], v[24:27], v[136:139]
    v_mfma_f32_16x16x32_bf16 v[140:143], v[56:59], v[28:31], v[140:143]
    ds_read_b128 v[40:43], v13 offset:36864
    v_mfma_f32_16x16x32_bf16 v[144:147], v[60:63], v[16:19], v[144:147]
    v_mfma_f32_16x16x32_bf16 v[148:151], v[60:63], v[20:23], v[148:151]
    ds_read_b64_tr_b16 v[84:85], v11 offset:61440
    ds_read_b64_tr_b16 v[86:87], v11 offset:61952
    v_mfma_f32_16x16x32_bf16 v[152:155], v[60:63], v[24:27], v[152:155]
    v_mfma_f32_16x16x32_bf16 v[156:159], v[60:63], v[28:31], v[156:159]
    ds_read_b128 v[44:47], v13 offset:38912
    s_waitcnt lgkmcnt(14)
    v_mfma_f32_16x16x32_bf16 v[160:163], v[64:67], v[16:19], v[160:163]
    v_mfma_f32_16x16x32_bf16 v[164:167], v[64:67], v[20:23], v[164:167]
    ds_read_b64_tr_b16 v[88:89], v14 offset:61440
    ds_read_b64_tr_b16 v[90:91], v14 offset:61952
    v_mfma_f32_16x16x32_bf16 v[168:171], v[64:67], v[24:27], v[168:171]
    v_mfma_f32_16x16x32_bf16 v[172:175], v[64:67], v[28:31], v[172:175]
    s_waitcnt lgkmcnt(14)
    v_mfma_f32_16x16x32_bf16 v[176:179], v[68:71], v[16:19], v[176:179]
    v_mfma_f32_16x16x32_bf16 v[180:183], v[68:71], v[20:23], v[180:183]
    ds_read_b64_tr_b16 v[92:93], v15 offset:61440
    ds_read_b64_tr_b16 v[94:95], v15 offset:61952
    v_mfma_f32_16x16x32_bf16 v[184:187], v[68:71], v[24:27], v[184:187]
    v_mfma_f32_16x16x32_bf16 v[188:191], v[68:71], v[28:31], v[188:191]
    s_waitcnt lgkmcnt(0)
    s_barrier
    v_mfma_f32_16x16x32_bf16 v[96:99], v[72:75], v[32:35], v[96:99]
    v_mfma_f32_16x16x32_bf16 v[100:103], v[72:75], v[36:39], v[100:103]
    ds_read_b64_tr_b16 v[48:49], v6 offset:0
    ds_read_b64_tr_b16 v[50:51], v6 offset:512
    v_mfma_f32_16x16x32_bf16 v[104:107], v[72:75], v[40:43], v[104:107]
    v_mfma_f32_16x16x32_bf16 v[108:111], v[72:75], v[44:47], v[108:111]
    ds_read_b128 v[16:19], v12 offset:0
    v_mfma_f32_16x16x32_bf16 v[112:115], v[76:79], v[32:35], v[112:115]
    v_mfma_f32_16x16x32_bf16 v[116:119], v[76:79], v[36:39], v[116:119]
    ds_read_b64_tr_b16 v[52:53], v9 offset:0
    ds_read_b64_tr_b16 v[54:55], v9 offset:512
    v_mfma_f32_16x16x32_bf16 v[120:123], v[76:79], v[40:43], v[120:123]
    v_mfma_f32_16x16x32_bf16 v[124:127], v[76:79], v[44:47], v[124:127]
    ds_read_b128 v[20:23], v12 offset:2048
    v_mfma_f32_16x16x32_bf16 v[128:131], v[80:83], v[32:35], v[128:131]
    v_mfma_f32_16x16x32_bf16 v[132:135], v[80:83], v[36:39], v[132:135]
    ds_read_b64_tr_b16 v[56:57], v10 offset:0
    ds_read_b64_tr_b16 v[58:59], v10 offset:512
    v_mfma_f32_16x16x32_bf16 v[136:139], v[80:83], v[40:43], v[136:139]
    v_mfma_f32_16x16x32_bf16 v[140:143], v[80:83], v[44:47], v[140:143]
    ds_read_b128 v[24:27], v12 offset:4096
    v_mfma_f32_16x16x32_bf16 v[144:147], v[84:87], v[32:35], v[144:147]
    v_mfma_f32_16x16x32_bf16 v[148:151], v[84:87], v[36:39], v[148:151]
    ds_read_b64_tr_b16 v[60:61], v11 offset:0
    ds_read_b64_tr_b16 v[62:63], v11 offset:512
    v_mfma_f32_16x16x32_bf16 v[152:155], v[84:87], v[40:43], v[152:155]
    v_mfma_f32_16x16x32_bf16 v[156:159], v[84:87], v[44:47], v[156:159]
    ds_read_b128 v[28:31], v12 offset:6144
    v_mfma_f32_16x16x32_bf16 v[160:163], v[88:91], v[32:35], v[160:163]
    v_mfma_f32_16x16x32_bf16 v[164:167], v[88:91], v[36:39], v[164:167]
    ds_read_b64_tr_b16 v[64:65], v14 offset:0
    ds_read_b64_tr_b16 v[66:67], v14 offset:512
    v_mfma_f32_16x16x32_bf16 v[168:171], v[88:91], v[40:43], v[168:171]
    v_mfma_f32_16x16x32_bf16 v[172:175], v[88:91], v[44:47], v[172:175]
    v_mfma_f32_16x16x32_bf16 v[176:179], v[92:95], v[32:35], v[176:179]
    v_mfma_f32_16x16x32_bf16 v[180:183], v[92:95], v[36:39], v[180:183]
    ds_read_b64_tr_b16 v[68:69], v15 offset:0
    ds_read_b64_tr_b16 v[70:71], v15 offset:512
    v_mfma_f32_16x16x32_bf16 v[184:187], v[92:95], v[40:43], v[184:187]
    v_mfma_f32_16x16x32_bf16 v[188:191], v[92:95], v[44:47], v[188:191]
    s_waitcnt lgkmcnt(14)
    s_waitcnt lgkmcnt(4)
    v_mfma_f32_16x16x32_bf16 v[96:99], v[48:51], v[16:19], v[96:99]
    v_mfma_f32_16x16x32_bf16 v[100:103], v[48:51], v[20:23], v[100:103]
    ds_read_b64_tr_b16 v[72:73], v6 offset:12288
    ds_read_b64_tr_b16 v[74:75], v6 offset:12800
    v_mfma_f32_16x16x32_bf16 v[104:107], v[48:51], v[24:27], v[104:107]
    v_mfma_f32_16x16x32_bf16 v[108:111], v[48:51], v[28:31], v[108:111]
    ds_read_b128 v[32:35], v13 offset:0
    v_mfma_f32_16x16x32_bf16 v[112:115], v[52:55], v[16:19], v[112:115]
    v_mfma_f32_16x16x32_bf16 v[116:119], v[52:55], v[20:23], v[116:119]
    ds_read_b64_tr_b16 v[76:77], v9 offset:12288
    ds_read_b64_tr_b16 v[78:79], v9 offset:12800
    v_mfma_f32_16x16x32_bf16 v[120:123], v[52:55], v[24:27], v[120:123]
    v_mfma_f32_16x16x32_bf16 v[124:127], v[52:55], v[28:31], v[124:127]
    ds_read_b128 v[36:39], v13 offset:2048
    v_mfma_f32_16x16x32_bf16 v[128:131], v[56:59], v[16:19], v[128:131]
    v_mfma_f32_16x16x32_bf16 v[132:135], v[56:59], v[20:23], v[132:135]
    ds_read_b64_tr_b16 v[80:81], v10 offset:12288
    ds_read_b64_tr_b16 v[82:83], v10 offset:12800
    v_mfma_f32_16x16x32_bf16 v[136:139], v[56:59], v[24:27], v[136:139]
    v_mfma_f32_16x16x32_bf16 v[140:143], v[56:59], v[28:31], v[140:143]
    ds_read_b128 v[40:43], v13 offset:4096
    v_mfma_f32_16x16x32_bf16 v[144:147], v[60:63], v[16:19], v[144:147]
    v_mfma_f32_16x16x32_bf16 v[148:151], v[60:63], v[20:23], v[148:151]
    ds_read_b64_tr_b16 v[84:85], v11 offset:12288
    ds_read_b64_tr_b16 v[86:87], v11 offset:12800
    v_mfma_f32_16x16x32_bf16 v[152:155], v[60:63], v[24:27], v[152:155]
    v_mfma_f32_16x16x32_bf16 v[156:159], v[60:63], v[28:31], v[156:159]
    ds_read_b128 v[44:47], v13 offset:6144
    s_waitcnt lgkmcnt(14)
    v_mfma_f32_16x16x32_bf16 v[160:163], v[64:67], v[16:19], v[160:163]
    v_mfma_f32_16x16x32_bf16 v[164:167], v[64:67], v[20:23], v[164:167]
    ds_read_b64_tr_b16 v[88:89], v14 offset:12288
    ds_read_b64_tr_b16 v[90:91], v14 offset:12800
    v_mfma_f32_16x16x32_bf16 v[168:171], v[64:67], v[24:27], v[168:171]
    v_mfma_f32_16x16x32_bf16 v[172:175], v[64:67], v[28:31], v[172:175]
    s_waitcnt lgkmcnt(14)
    v_mfma_f32_16x16x32_bf16 v[176:179], v[68:71], v[16:19], v[176:179]
    v_mfma_f32_16x16x32_bf16 v[180:183], v[68:71], v[20:23], v[180:183]
    ds_read_b64_tr_b16 v[92:93], v15 offset:12288
    ds_read_b64_tr_b16 v[94:95], v15 offset:12800
    v_mfma_f32_16x16x32_bf16 v[184:187], v[68:71], v[24:27], v[184:187]
    v_mfma_f32_16x16x32_bf16 v[188:191], v[68:71], v[28:31], v[188:191]
    s_waitcnt lgkmcnt(14)
    s_waitcnt lgkmcnt(4)
    v_mfma_f32_16x16x32_bf16 v[96:99], v[72:75], v[32:35], v[96:99]
    v_mfma_f32_16x16x32_bf16 v[100:103], v[72:75], v[36:39], v[100:103]
    v_mfma_f32_16x16x32_bf16 v[104:107], v[72:75], v[40:43], v[104:107]
    v_mfma_f32_16x16x32_bf16 v[108:111], v[72:75], v[44:47], v[108:111]
    v_mfma_f32_16x16x32_bf16 v[112:115], v[76:79], v[32:35], v[112:115]
    s_nop 3
    v_mul_f32 v96, v96, v204
    v_mul_f32 v97, v97, v204
    v_mul_f32 v98, v98, v204
    v_mul_f32 v99, v99, v204
    v_cvt_pk_bf16_f32 v96, v96, v97
    v_cvt_pk_bf16_f32 v97, v98, v99
    buffer_store_dwordx2 v[96:97], v192, s[32:35], s58 offen sc1
    v_mfma_f32_16x16x32_bf16 v[116:119], v[76:79], v[36:39], v[116:119]
    v_mul_f32 v100, v100, v204
    v_mul_f32 v101, v101, v204
    v_mul_f32 v102, v102, v204
    v_mul_f32 v103, v103, v204
    v_cvt_pk_bf16_f32 v100, v100, v101
    v_cvt_pk_bf16_f32 v101, v102, v103
    buffer_store_dwordx2 v[100:101], v198, s[32:35], s58 offen sc1
    v_mfma_f32_16x16x32_bf16 v[120:123], v[76:79], v[40:43], v[120:123]
    v_mul_f32 v104, v104, v204
    v_mul_f32 v105, v105, v204
    v_mul_f32 v106, v106, v204
    v_mul_f32 v107, v107, v204
    v_cvt_pk_bf16_f32 v104, v104, v105
    v_cvt_pk_bf16_f32 v105, v106, v107
    buffer_store_dwordx2 v[104:105], v192, s[32:35], s59 offen sc1
    v_mfma_f32_16x16x32_bf16 v[124:127], v[76:79], v[44:47], v[124:127]
    v_mul_f32 v108, v108, v204
    v_mul_f32 v109, v109, v204
    v_mul_f32 v110, v110, v204
    v_mul_f32 v111, v111, v204
    v_cvt_pk_bf16_f32 v108, v108, v109
    v_cvt_pk_bf16_f32 v109, v110, v111
    buffer_store_dwordx2 v[108:109], v198, s[32:35], s59 offen sc1
    v_mfma_f32_16x16x32_bf16 v[128:131], v[80:83], v[32:35], v[128:131]
    v_mul_f32 v112, v112, v205
    v_mul_f32 v113, v113, v205
    v_mul_f32 v114, v114, v205
    v_mul_f32 v115, v115, v205
    v_cvt_pk_bf16_f32 v112, v112, v113
    v_cvt_pk_bf16_f32 v113, v114, v115
    buffer_store_dwordx2 v[112:113], v193, s[32:35], s58 offen sc1
    v_mfma_f32_16x16x32_bf16 v[132:135], v[80:83], v[36:39], v[132:135]
    v_mul_f32 v116, v116, v205
    v_mul_f32 v117, v117, v205
    v_mul_f32 v118, v118, v205
    v_mul_f32 v119, v119, v205
    v_cvt_pk_bf16_f32 v116, v116, v117
    v_cvt_pk_bf16_f32 v117, v118, v119
    buffer_store_dwordx2 v[116:117], v199, s[32:35], s58 offen sc1
    v_mfma_f32_16x16x32_bf16 v[136:139], v[80:83], v[40:43], v[136:139]
    v_mul_f32 v120, v120, v205
    v_mul_f32 v121, v121, v205
    v_mul_f32 v122, v122, v205
    v_mul_f32 v123, v123, v205
    v_cvt_pk_bf16_f32 v120, v120, v121
    v_cvt_pk_bf16_f32 v121, v122, v123
    buffer_store_dwordx2 v[120:121], v193, s[32:35], s59 offen sc1
    v_mfma_f32_16x16x32_bf16 v[140:143], v[80:83], v[44:47], v[140:143]
    v_mul_f32 v124, v124, v205
    v_mul_f32 v125, v125, v205
    v_mul_f32 v126, v126, v205
    v_mul_f32 v127, v127, v205
    v_cvt_pk_bf16_f32 v124, v124, v125
    v_cvt_pk_bf16_f32 v125, v126, v127
    buffer_store_dwordx2 v[124:125], v199, s[32:35], s59 offen sc1
    v_mfma_f32_16x16x32_bf16 v[144:147], v[84:87], v[32:35], v[144:147]
    v_mul_f32 v128, v128, v206
    v_mul_f32 v129, v129, v206
    v_mul_f32 v130, v130, v206
    v_mul_f32 v131, v131, v206
    v_cvt_pk_bf16_f32 v128, v128, v129
    v_cvt_pk_bf16_f32 v129, v130, v131
    buffer_store_dwordx2 v[128:129], v194, s[32:35], s58 offen sc1
    v_mfma_f32_16x16x32_bf16 v[148:151], v[84:87], v[36:39], v[148:151]
    v_mul_f32 v132, v132, v206
    v_mul_f32 v133, v133, v206
    v_mul_f32 v134, v134, v206
    v_mul_f32 v135, v135, v206
    v_cvt_pk_bf16_f32 v132, v132, v133
    v_cvt_pk_bf16_f32 v133, v134, v135
    buffer_store_dwordx2 v[132:133], v200, s[32:35], s58 offen sc1
    v_mfma_f32_16x16x32_bf16 v[152:155], v[84:87], v[40:43], v[152:155]
    v_mul_f32 v136, v136, v206
    v_mul_f32 v137, v137, v206
    v_mul_f32 v138, v138, v206
    v_mul_f32 v139, v139, v206
    v_cvt_pk_bf16_f32 v136, v136, v137
    v_cvt_pk_bf16_f32 v137, v138, v139
    buffer_store_dwordx2 v[136:137], v194, s[32:35], s59 offen sc1
    v_mfma_f32_16x16x32_bf16 v[156:159], v[84:87], v[44:47], v[156:159]
    v_mul_f32 v140, v140, v206
    v_mul_f32 v141, v141, v206
    v_mul_f32 v142, v142, v206
    v_mul_f32 v143, v143, v206
    v_cvt_pk_bf16_f32 v140, v140, v141
    v_cvt_pk_bf16_f32 v141, v142, v143
    buffer_store_dwordx2 v[140:141], v200, s[32:35], s59 offen sc1
    s_waitcnt lgkmcnt(2)
    v_mfma_f32_16x16x32_bf16 v[160:163], v[88:91], v[32:35], v[160:163]
    v_mul_f32 v144, v144, v207
    v_mul_f32 v145, v145, v207
    v_mul_f32 v146, v146, v207
    v_mul_f32 v147, v147, v207
    v_cvt_pk_bf16_f32 v144, v144, v145
    v_cvt_pk_bf16_f32 v145, v146, v147
    buffer_store_dwordx2 v[144:145], v195, s[32:35], s58 offen sc1
    v_mfma_f32_16x16x32_bf16 v[164:167], v[88:91], v[36:39], v[164:167]
    v_mul_f32 v148, v148, v207
    v_mul_f32 v149, v149, v207
    v_mul_f32 v150, v150, v207
    v_mul_f32 v151, v151, v207
    v_cvt_pk_bf16_f32 v148, v148, v149
    v_cvt_pk_bf16_f32 v149, v150, v151
    buffer_store_dwordx2 v[148:149], v201, s[32:35], s58 offen sc1
    v_mfma_f32_16x16x32_bf16 v[168:171], v[88:91], v[40:43], v[168:171]
    v_mul_f32 v152, v152, v207
    v_mul_f32 v153, v153, v207
    v_mul_f32 v154, v154, v207
    v_mul_f32 v155, v155, v207
    v_cvt_pk_bf16_f32 v152, v152, v153
    v_cvt_pk_bf16_f32 v153, v154, v155
    buffer_store_dwordx2 v[152:153], v195, s[32:35], s59 offen sc1
    v_mfma_f32_16x16x32_bf16 v[172:175], v[88:91], v[44:47], v[172:175]
    v_mul_f32 v156, v156, v207
    v_mul_f32 v157, v157, v207
    v_mul_f32 v158, v158, v207
    v_mul_f32 v159, v159, v207
    v_cvt_pk_bf16_f32 v156, v156, v157
    v_cvt_pk_bf16_f32 v157, v158, v159
    buffer_store_dwordx2 v[156:157], v201, s[32:35], s59 offen sc1
    s_waitcnt lgkmcnt(0)
    v_mfma_f32_16x16x32_bf16 v[176:179], v[92:95], v[32:35], v[176:179]
    v_mul_f32 v160, v160, v208
    v_mul_f32 v161, v161, v208
    v_mul_f32 v162, v162, v208
    v_mul_f32 v163, v163, v208
    v_cvt_pk_bf16_f32 v160, v160, v161
    v_cvt_pk_bf16_f32 v161, v162, v163
    buffer_store_dwordx2 v[160:161], v196, s[32:35], s58 offen sc1
    v_mfma_f32_16x16x32_bf16 v[180:183], v[92:95], v[36:39], v[180:183]
    v_mul_f32 v164, v164, v208
    v_mul_f32 v165, v165, v208
    v_mul_f32 v166, v166, v208
    v_mul_f32 v167, v167, v208
    v_cvt_pk_bf16_f32 v164, v164, v165
    v_cvt_pk_bf16_f32 v165, v166, v167
    buffer_store_dwordx2 v[164:165], v202, s[32:35], s58 offen sc1
    v_mfma_f32_16x16x32_bf16 v[184:187], v[92:95], v[40:43], v[184:187]
    v_mul_f32 v168, v168, v208
    v_mul_f32 v169, v169, v208
    v_mul_f32 v170, v170, v208
    v_mul_f32 v171, v171, v208
    v_cvt_pk_bf16_f32 v168, v168, v169
    v_cvt_pk_bf16_f32 v169, v170, v171
    buffer_store_dwordx2 v[168:169], v196, s[32:35], s59 offen sc1
    v_mfma_f32_16x16x32_bf16 v[188:191], v[92:95], v[44:47], v[188:191]
    v_mul_f32 v172, v172, v208
    v_mul_f32 v173, v173, v208
    v_mul_f32 v174, v174, v208
    v_mul_f32 v175, v175, v208
    v_cvt_pk_bf16_f32 v172, v172, v173
    v_cvt_pk_bf16_f32 v173, v174, v175
    buffer_store_dwordx2 v[172:173], v202, s[32:35], s59 offen sc1
    v_mul_f32 v176, v176, v209
    v_mul_f32 v177, v177, v209
    v_mul_f32 v178, v178, v209
    v_mul_f32 v179, v179, v209
    v_cvt_pk_bf16_f32 v176, v176, v177
    v_cvt_pk_bf16_f32 v177, v178, v179
    buffer_store_dwordx2 v[176:177], v197, s[32:35], s58 offen sc1
    v_mul_f32 v180, v180, v209
    v_mul_f32 v181, v181, v209
    v_mul_f32 v182, v182, v209
    v_mul_f32 v183, v183, v209
    v_cvt_pk_bf16_f32 v180, v180, v181
    v_cvt_pk_bf16_f32 v181, v182, v183
    buffer_store_dwordx2 v[180:181], v203, s[32:35], s58 offen sc1
    v_mul_f32 v184, v184, v209
    v_mul_f32 v185, v185, v209
    v_mul_f32 v186, v186, v209
    v_mul_f32 v187, v187, v209
    v_cvt_pk_bf16_f32 v184, v184, v185
    v_cvt_pk_bf16_f32 v185, v186, v187
    buffer_store_dwordx2 v[184:185], v197, s[32:35], s59 offen sc1
    v_mul_f32 v188, v188, v209
    v_mul_f32 v189, v189, v209
    v_mul_f32 v190, v190, v209
    v_mul_f32 v191, v191, v209
    v_cvt_pk_bf16_f32 v188, v188, v189
    v_cvt_pk_bf16_f32 v189, v190, v191
    buffer_store_dwordx2 v[188:189], v203, s[32:35], s59 offen sc1
    s_endpgm
L_load_qkv_kernel:
    v_lshrrev_b32 v5, 3, v2
    v_and_b32 v8, 7, v2
    s_lshl_b32 s45, s42, 7
    s_lshl_b32 s46, s43, 5
    s_add_u32 s45, s45, s46
    v_add_u32 v6, s45, v5
    v_mul_u32_u24 v6, 896, v6
    v_lshrrev_b32 v7, 1, v5
    v_xor_b32 v9, v7, v8
    v_lshl_add_u32 v11, v9, 4, v6
    v_xor_b32 v9, 4, v9
    v_lshl_add_u32 v6, v9, 4, v6
    v_add_u32 v6, 7168, v6
    s_lshl_b32 s58, s43, 12
    s_add_u32 s58, s58, 73728
    s_lshl_b32 s46, s43, 4
    v_add_u32 v9, s46, v5
    v_mul_u32_u24 v9, 2688, v9
    s_mul_i32 s47, s41, 384
    v_add_u32 v9, s47, v9
    v_and_b32 v7, 1, v7
    v_lshlrev_b32 v7, 2, v7
    v_xor_b32 v7, v7, v8
    v_lshl_add_u32 v10, v7, 4, v9
    v_xor_b32 v7, 2, v7
    v_lshl_add_u32 v9, v7, 4, v9
    v_add_u32 v9, 21504, v9
    s_mul_i32 s48, s43, 6144
    s_waitcnt lgkmcnt(0)
    s_cmp_eq_u32 s38, 0
    s_cselect_b32 s52, s4, s10
    s_cselect_b32 s53, s5, s11
    s_cselect_b32 s54, s6, s12
    s_cselect_b32 s55, s7, s13
    s_mov_b32 s24, s52
    s_and_b32 s25, s53, 0xffff
    s_mov_b32 s26, 1835008
    s_mov_b32 s27, 0x00020000
    s_mov_b32 s28, s54
    s_and_b32 s29, s55, 0xffff
    s_mov_b32 s30, 1204224
    s_mov_b32 s31, 0x00020000
    s_mul_i32 s56, s38, 6291456
    s_add_u32 s52, s20, s56
    s_addc_u32 s53, s21, 0
    s_mov_b32 s32, s52
    s_and_b32 s33, s53, 0xffff
    s_mov_b32 s34, 6291456
    s_mov_b32 s35, 0x00020000
    s_add_u32 s57, s48, 0
    s_mov_b32 m0, s57
    s_mov_b32 s59, 0
    buffer_load_dwordx4 v10, s[28:31], s59 offen lds
    s_add_u32 s57, s48, 1024
    s_mov_b32 m0, s57
    s_mov_b32 s59, 128
    buffer_load_dwordx4 v10, s[28:31], s59 offen lds
    s_add_u32 s57, s48, 2048
    s_mov_b32 m0, s57
    s_mov_b32 s59, 256
    buffer_load_dwordx4 v10, s[28:31], s59 offen lds
    s_add_u32 s57, s48, 3072
    s_mov_b32 m0, s57
    s_mov_b32 s59, 0
    buffer_load_dwordx4 v9, s[28:31], s59 offen lds
    s_add_u32 s57, s48, 4096
    s_mov_b32 m0, s57
    s_mov_b32 s59, 128
    buffer_load_dwordx4 v9, s[28:31], s59 offen lds
    s_add_u32 s57, s48, 5120
    s_mov_b32 m0, s57
    s_mov_b32 s59, 256
    buffer_load_dwordx4 v9, s[28:31], s59 offen lds
    s_add_u32 s57, s58, 0
    s_mov_b32 m0, s57
    s_mov_b32 s59, 0
    buffer_load_dwordx4 v11, s[24:27], s59 offen lds
    s_add_u32 s57, s58, 1024
    s_mov_b32 m0, s57
    s_mov_b32 s59, 0
    buffer_load_dwordx4 v6, s[24:27], s59 offen lds
    s_add_u32 s57, s58, 2048
    s_mov_b32 m0, s57
    s_mov_b32 s59, 14336
    buffer_load_dwordx4 v11, s[24:27], s59 offen lds
    s_add_u32 s57, s58, 3072
    s_mov_b32 m0, s57
    s_mov_b32 s59, 14336
    buffer_load_dwordx4 v6, s[24:27], s59 offen lds
    s_add_u32 s57, s48, 24576
    s_mov_b32 m0, s57
    s_mov_b32 s59, 172032
    buffer_load_dwordx4 v10, s[28:31], s59 offen lds
    s_add_u32 s57, s48, 25600
    s_mov_b32 m0, s57
    s_mov_b32 s59, 172160
    buffer_load_dwordx4 v10, s[28:31], s59 offen lds
    s_add_u32 s57, s48, 26624
    s_mov_b32 m0, s57
    s_mov_b32 s59, 172288
    buffer_load_dwordx4 v10, s[28:31], s59 offen lds
    s_add_u32 s57, s48, 27648
    s_mov_b32 m0, s57
    s_mov_b32 s59, 172032
    buffer_load_dwordx4 v9, s[28:31], s59 offen lds
    s_add_u32 s57, s48, 28672
    s_mov_b32 m0, s57
    s_mov_b32 s59, 172160
    buffer_load_dwordx4 v9, s[28:31], s59 offen lds
    s_add_u32 s57, s48, 29696
    s_mov_b32 m0, s57
    s_mov_b32 s59, 172288
    buffer_load_dwordx4 v9, s[28:31], s59 offen lds
    s_add_u32 s57, s58, 16384
    s_mov_b32 m0, s57
    s_mov_b32 s59, 128
    buffer_load_dwordx4 v11, s[24:27], s59 offen lds
    s_add_u32 s57, s58, 17408
    s_mov_b32 m0, s57
    s_mov_b32 s59, 128
    buffer_load_dwordx4 v6, s[24:27], s59 offen lds
    s_add_u32 s57, s58, 18432
    s_mov_b32 m0, s57
    s_mov_b32 s59, 14464
    buffer_load_dwordx4 v11, s[24:27], s59 offen lds
    s_add_u32 s57, s58, 19456
    s_mov_b32 m0, s57
    s_mov_b32 s59, 14464
    buffer_load_dwordx4 v6, s[24:27], s59 offen lds
    v_and_b32 v5, 31, v2
    v_lshrrev_b32 v7, 5, v2
    s_mul_i32 s46, s41, 7
    s_lshl_b32 s45, s42, 2
    s_add_u32 s45, s45, s43
    s_lshl_b32 s45, s45, 11
    v_add_u32 v12, 0, v7
    v_add_u32 v8, s46, v12
    v_mul_u32_u24 v13, 0x5556, v8
    v_lshrrev_b32 v13, 16, v13
    v_mul_u32_u24 v13, 3, v13
    v_sub_u32 v13, v8, v13
    v_cmp_eq_u32 vcc, 2, v13
    v_mov_b32 v16, 0x3f80
    s_nop 0
    v_cndmask_b32 v16, 0, v16, vcc
    v_mov_b32 v17, 0
    v_cndmask_b32 v13, 0, 28, vcc
    v_xor_b32 v13, v13, v5
    v_lshlrev_b32 v13, 3, v13
    v_lshl_add_u32 v13, v8, 17, v13
    v_add_u32 v13, 1792, v13
    v_cmp_gt_u32 vcc, 7, v12
    v_mov_b32 v14, 0x7f000000
    s_nop 0
    v_cndmask_b32 v18, v14, v13, vcc
    v_add_u32 v12, 2, v7
    v_add_u32 v8, s46, v12
    v_mul_u32_u24 v13, 0x5556, v8
    v_lshrrev_b32 v13, 16, v13
    v_mul_u32_u24 v13, 3, v13
    v_sub_u32 v13, v8, v13
    v_cmp_eq_u32 vcc, 2, v13
    v_mov_b32 v20, 0x3f80
    s_nop 0
    v_cndmask_b32 v20, 0, v20, vcc
    v_mov_b32 v21, 0
    v_cndmask_b32 v13, 0, 28, vcc
    v_xor_b32 v13, v13, v5
    v_lshlrev_b32 v13, 3, v13
    v_lshl_add_u32 v13, v8, 17, v13
    v_add_u32 v13, 1792, v13
    v_cmp_gt_u32 vcc, 7, v12
    v_mov_b32 v14, 0x7f000000
    s_nop 0
    v_cndmask_b32 v22, v14, v13, vcc
    v_add_u32 v12, 4, v7
    v_add_u32 v8, s46, v12
    v_mul_u32_u24 v13, 0x5556, v8
    v_lshrrev_b32 v13, 16, v13
    v_mul_u32_u24 v13, 3, v13
    v_sub_u32 v13, v8, v13
    v_cmp_eq_u32 vcc, 2, v13
    v_mov_b32 v24, 0x3f80
    s_nop 0
    v_cndmask_b32 v24, 0, v24, vcc
    v_mov_b32 v25, 0
    v_cndmask_b32 v13, 0, 28, vcc
    v_xor_b32 v13, v13, v5
    v_lshlrev_b32 v13, 3, v13
    v_lshl_add_u32 v13, v8, 17, v13
    v_add_u32 v13, 1792, v13
    v_cmp_gt_u32 vcc, 7, v12
    v_mov_b32 v14, 0x7f000000
    s_nop 0
    v_cndmask_b32 v26, v14, v13, vcc
    v_add_u32 v12, 6, v7
    v_add_u32 v8, s46, v12
    v_mul_u32_u24 v13, 0x5556, v8
    v_lshrrev_b32 v13, 16, v13
    v_mul_u32_u24 v13, 3, v13
    v_sub_u32 v13, v8, v13
    v_cmp_eq_u32 vcc, 2, v13
    v_mov_b32 v28, 0x3f80
    s_nop 0
    v_cndmask_b32 v28, 0, v28, vcc
    v_mov_b32 v29, 0
    v_cndmask_b32 v13, 0, 28, vcc
    v_xor_b32 v13, v13, v5
    v_lshlrev_b32 v13, 3, v13
    v_lshl_add_u32 v13, v8, 17, v13
    v_add_u32 v13, 1792, v13
    v_cmp_gt_u32 vcc, 7, v12
    v_mov_b32 v14, 0x7f000000
    s_nop 0
    v_cndmask_b32 v30, v14, v13, vcc
    s_waitcnt vmcnt(10)
    s_barrier
    s_add_u32 s57, s48, 49152
    s_mov_b32 m0, s57
    s_mov_b32 s59, 344064
    buffer_load_dwordx4 v10, s[28:31], s59 offen lds
    s_add_u32 s57, s48, 50176
    s_mov_b32 m0, s57
    s_mov_b32 s59, 344192
    buffer_load_dwordx4 v10, s[28:31], s59 offen lds
    s_add_u32 s57, s48, 51200
    s_mov_b32 m0, s57
    s_mov_b32 s59, 344320
    buffer_load_dwordx4 v10, s[28:31], s59 offen lds
    s_add_u32 s57, s48, 52224
    s_mov_b32 m0, s57
    s_mov_b32 s59, 344064
    buffer_load_dwordx4 v9, s[28:31], s59 offen lds
    s_add_u32 s57, s48, 53248
    s_mov_b32 m0, s57
    s_mov_b32 s59, 344192
    buffer_load_dwordx4 v9, s[28:31], s59 offen lds
    s_add_u32 s57, s48, 54272
    s_mov_b32 m0, s57
    s_mov_b32 s59, 344320
    buffer_load_dwordx4 v9, s[28:31], s59 offen lds
    s_add_u32 s57, s58, 32768
    s_mov_b32 m0, s57
    s_mov_b32 s59, 256
    buffer_load_dwordx4 v11, s[24:27], s59 offen lds
    s_add_u32 s57, s58, 33792
    s_mov_b32 m0, s57
    s_mov_b32 s59, 256
    buffer_load_dwordx4 v6, s[24:27], s59 offen lds
    s_add_u32 s57, s58, 34816
    s_mov_b32 m0, s57
    s_mov_b32 s59, 14592
    buffer_load_dwordx4 v11, s[24:27], s59 offen lds
    s_add_u32 s57, s58, 35840
    s_mov_b32 m0, s57
    s_mov_b32 s59, 14592
    buffer_load_dwordx4 v6, s[24:27], s59 offen lds
    s_waitcnt vmcnt(10)
    s_barrier
    s_add_u32 s57, s48, 0
    s_mov_b32 m0, s57
    s_mov_b32 s59, 516096
    buffer_load_dwordx4 v10, s[28:31], s59 offen lds
    s_add_u32 s57, s48, 1024
    s_mov_b32 m0, s57
    s_mov_b32 s59, 516224
    buffer_load_dwordx4 v10, s[28:31], s59 offen lds
    s_add_u32 s57, s48, 2048
    s_mov_b32 m0, s57
    s_mov_b32 s59, 516352
    buffer_load_dwordx4 v10, s[28:31], s59 offen lds
    s_add_u32 s57, s48, 3072
    s_mov_b32 m0, s57
    s_mov_b32 s59, 516096
    buffer_load_dwordx4 v9, s[28:31], s59 offen lds
    s_add_u32 s57, s48, 4096
    s_mov_b32 m0, s57
    s_mov_b32 s59, 516224
    buffer_load_dwordx4 v9, s[28:31], s59 offen lds
    s_add_u32 s57, s48, 5120
    s_mov_b32 m0, s57
    s_mov_b32 s59, 516352
    buffer_load_dwordx4 v9, s[28:31], s59 offen lds
    s_add_u32 s57, s58, 0
    s_mov_b32 m0, s57
    s_mov_b32 s59, 384
    buffer_load_dwordx4 v11, s[24:27], s59 offen lds
    s_add_u32 s57, s58, 1024
    s_mov_b32 m0, s57
    s_mov_b32 s59, 384
    buffer_load_dwordx4 v6, s[24:27], s59 offen lds
    s_add_u32 s57, s58, 2048
    s_mov_b32 m0, s57
    s_mov_b32 s59, 14720
    buffer_load_dwordx4 v11, s[24:27], s59 offen lds
    s_add_u32 s57, s58, 3072
    s_mov_b32 m0, s57
    s_mov_b32 s59, 14720
    buffer_load_dwordx4 v6, s[24:27], s59 offen lds
    s_waitcnt vmcnt(10)
    s_barrier
    s_add_u32 s57, s48, 24576
    s_mov_b32 m0, s57
    s_mov_b32 s59, 688128
    buffer_load_dwordx4 v10, s[28:31], s59 offen lds
    s_add_u32 s57, s48, 25600
    s_mov_b32 m0, s57
    s_mov_b32 s59, 688256
    buffer_load_dwordx4 v10, s[28:31], s59 offen lds
    s_add_u32 s57, s48, 26624
    s_mov_b32 m0, s57
    s_mov_b32 s59, 688384
    buffer_load_dwordx4 v10, s[28:31], s59 offen lds
    s_add_u32 s57, s48, 27648
    s_mov_b32 m0, s57
    s_mov_b32 s59, 688128
    buffer_load_dwordx4 v9, s[28:31], s59 offen lds
    s_add_u32 s57, s48, 28672
    s_mov_b32 m0, s57
    s_mov_b32 s59, 688256
    buffer_load_dwordx4 v9, s[28:31], s59 offen lds
    s_add_u32 s57, s48, 29696
    s_mov_b32 m0, s57
    s_mov_b32 s59, 688384
    buffer_load_dwordx4 v9, s[28:31], s59 offen lds
    s_add_u32 s57, s58, 16384
    s_mov_b32 m0, s57
    s_mov_b32 s59, 512
    buffer_load_dwordx4 v11, s[24:27], s59 offen lds
    s_add_u32 s57, s58, 17408
    s_mov_b32 m0, s57
    s_mov_b32 s59, 512
    buffer_load_dwordx4 v6, s[24:27], s59 offen lds
    s_add_u32 s57, s58, 18432
    s_mov_b32 m0, s57
    s_mov_b32 s59, 14848
    buffer_load_dwordx4 v11, s[24:27], s59 offen lds
    s_add_u32 s57, s58, 19456
    s_mov_b32 m0, s57
    s_mov_b32 s59, 14848
    buffer_load_dwordx4 v6, s[24:27], s59 offen lds
    s_waitcnt vmcnt(10)
    s_barrier
    s_add_u32 s57, s48, 49152
    s_mov_b32 m0, s57
    s_mov_b32 s59, 860160
    buffer_load_dwordx4 v10, s[28:31], s59 offen lds
    s_add_u32 s57, s48, 50176
    s_mov_b32 m0, s57
    s_mov_b32 s59, 860288
    buffer_load_dwordx4 v10, s[28:31], s59 offen lds
    s_add_u32 s57, s48, 51200
    s_mov_b32 m0, s57
    s_mov_b32 s59, 860416
    buffer_load_dwordx4 v10, s[28:31], s59 offen lds
    s_add_u32 s57, s48, 52224
    s_mov_b32 m0, s57
    s_mov_b32 s59, 860160
    buffer_load_dwordx4 v9, s[28:31], s59 offen lds
    s_add_u32 s57, s48, 53248
    s_mov_b32 m0, s57
    s_mov_b32 s59, 860288
    buffer_load_dwordx4 v9, s[28:31], s59 offen lds
    s_add_u32 s57, s48, 54272
    s_mov_b32 m0, s57
    s_mov_b32 s59, 860416
    buffer_load_dwordx4 v9, s[28:31], s59 offen lds
    s_add_u32 s57, s58, 32768
    s_mov_b32 m0, s57
    s_mov_b32 s59, 640
    buffer_load_dwordx4 v11, s[24:27], s59 offen lds
    s_add_u32 s57, s58, 33792
    s_mov_b32 m0, s57
    s_mov_b32 s59, 640
    buffer_load_dwordx4 v6, s[24:27], s59 offen lds
    s_add_u32 s57, s58, 34816
    s_mov_b32 m0, s57
    s_mov_b32 s59, 14976
    buffer_load_dwordx4 v11, s[24:27], s59 offen lds
    s_add_u32 s57, s58, 35840
    s_mov_b32 m0, s57
    s_mov_b32 s59, 14976
    buffer_load_dwordx4 v6, s[24:27], s59 offen lds
    s_waitcnt vmcnt(10)
    s_barrier
    s_add_u32 s57, s48, 0
    s_mov_b32 m0, s57
    s_mov_b32 s59, 1032192
    buffer_load_dwordx4 v10, s[28:31], s59 offen lds
    s_add_u32 s57, s48, 1024
    s_mov_b32 m0, s57
    s_mov_b32 s59, 1032320
    buffer_load_dwordx4 v10, s[28:31], s59 offen lds
    s_add_u32 s57, s48, 2048
    s_mov_b32 m0, s57
    s_mov_b32 s59, 1032448
    buffer_load_dwordx4 v10, s[28:31], s59 offen lds
    s_add_u32 s57, s48, 3072
    s_mov_b32 m0, s57
    s_mov_b32 s59, 1032192
    buffer_load_dwordx4 v9, s[28:31], s59 offen lds
    s_add_u32 s57, s48, 4096
    s_mov_b32 m0, s57
    s_mov_b32 s59, 1032320
    buffer_load_dwordx4 v9, s[28:31], s59 offen lds
    s_add_u32 s57, s48, 5120
    s_mov_b32 m0, s57
    s_mov_b32 s59, 1032448
    buffer_load_dwordx4 v9, s[28:31], s59 offen lds
    s_add_u32 s57, s58, 0
    s_mov_b32 m0, s57
    s_mov_b32 s59, 768
    buffer_load_dwordx4 v11, s[24:27], s59 offen lds
    s_add_u32 s57, s58, 1024
    s_mov_b32 m0, s57
    s_mov_b32 s59, 768
    buffer_load_dwordx4 v6, s[24:27], s59 offen lds
    s_add_u32 s57, s58, 2048
    s_mov_b32 m0, s57
    s_mov_b32 s59, 15104
    buffer_load_dwordx4 v11, s[24:27], s59 offen lds
    s_add_u32 s57, s58, 3072
    s_mov_b32 m0, s57
    s_mov_b32 s59, 15104
    buffer_load_dwordx4 v6, s[24:27], s59 offen lds
    s_waitcnt vmcnt(10)
    s_barrier
    s_waitcnt vmcnt(0)
    s_barrier
    buffer_store_dwordx2 v[16:17], v18, s[32:35], s45 offen sc1
    buffer_store_dwordx2 v[20:21], v22, s[32:35], s45 offen sc1
    buffer_store_dwordx2 v[24:25], v26, s[32:35], s45 offen sc1
    buffer_store_dwordx2 v[28:29], v30, s[32:35], s45 offen sc1
L_end_qkv_kernel:
    s_endpgm
.p2align 8
.globl attn_kernel
.type attn_kernel,@function
attn_kernel:
    s_cmp_ge_u32 s2, 256
    s_cbranch_scc1 L_end_attn_kernel
    s_load_dwordx16 s[4:19], s[0:1], 0
    s_load_dwordx2 s[20:21], s[0:1], 64
    v_lshrrev_b32 v1, 6, v0
    v_and_b32 v2, 63, v0
    v_readfirstlane_b32 s40, v1
    s_and_b32 s36, s2, 7
    s_lshr_b32 s37, s2, 3
    s_lshr_b32 s38, s36, 2
    s_and_b32 s36, s36, 3
    s_and_b32 s39, s37, 15
    s_lshr_b32 s41, s37, 4
    s_lshl_b32 s42, s36, 1
    s_add_u32 s42, s42, s41
    v_and_b32 v3, 31, v2
    v_lshrrev_b32 v4, 5, v2
    v_lshlrev_b32 v5, 4, v2
    s_lshl_b32 s43, s42, 14
    s_lshl_b32 s44, s40, 12
    s_add_u32 s45, s43, s44
    s_sub_u32 s45, s45, 16384
    v_add_u32 v7, s45, v5
    v_lshlrev_b32 v6, 3, v3
    v_lshl_add_u32 v6, v4, 9, v6
    s_lshl_b32 s46, s40, 11
    s_add_u32 s47, s43, s46
    v_add_u32 v10, s47, v6
    v_add_u32 v12, s46, v6
    v_bfe_u32 v6, v2, 4, 1
    v_and_b32 v8, 3, v2
    v_lshl_add_u32 v6, v6, 2, v8
    v_bfe_u32 v8, v2, 2, 2
    v_lshl_add_u32 v8, v4, 2, v8
    v_lshlrev_b32 v9, 2, v6
    v_xor_b32 v8, v8, v9
    v_lshlrev_b32 v9, 8, v6
    v_add_u32 v9, s46, v9
    v_add_u32 v9, 32768, v9
    v_lshl_add_u32 v13, v8, 3, v9
    v_xor_b32 v14, 64, v13
    v_xor_b32 v15, 128, v13
    v_xor_b32 v1, 192, v13
    s_mul_i32 s48, s39, 7
    v_add_u32 v8, s48, v4
    v_lshrrev_b32 v9, 1, v8
    v_lshlrev_b32 v9, 8, v9
    v_and_b32 v8, 1, v8
    v_lshl_add_u32 v9, v8, 3, v9
    v_and_b32 v8, 15, v3
    v_lshl_add_u32 v9, v8, 4, v9
    s_lshl_b32 s49, s42, 4
    s_lshl_b32 s50, s40, 1
    s_add_u32 s49, s49, s50
    v_lshrrev_b32 v8, 4, v3
    v_add_u32 v8, s49, v8
    v_mul_u32_u24 v8, 14336, v8
    v_add_u32 v11, v8, v9
    s_waitcnt lgkmcnt(0)
    s_lshl_b32 s56, s38, 4
    s_add_u32 s56, s56, s39
    s_mul_i32 s56, s56, 393216
    s_add_u32 s52, s20, s56
    s_addc_u32 s53, s21, 0
    s_mov_b32 s24, s52
    s_and_b32 s25, s53, 0xffff
    s_mov_b32 s26, 131072
    s_mov_b32 s27, 0x00020000
    s_add_u32 s52, s52, 131072
    s_addc_u32 s53, s53, 0
    s_mov_b32 s28, s52
    s_and_b32 s29, s53, 0xffff
    s_mov_b32 s30, 131072
    s_mov_b32 s31, 0x00020000
    s_add_u32 s52, s52, 131072
    s_addc_u32 s53, s53, 0
    s_mov_b32 s32, s52
    s_and_b32 s33, s53, 0xffff
    s_mov_b32 s34, 131072
    s_mov_b32 s35, 0x00020000
    s_mul_i32 s56, s38, 1835008
    s_add_u32 s56, s56, 12582912
    s_add_u32 s52, s20, s56
    s_addc_u32 s53, s21, 0
    s_mov_b32 s60, s52
    s_and_b32 s61, s53, 0xffff
    s_mov_b32 s62, 1835008
    s_mov_b32 s63, 0x00020000
    s_cmp_eq_u32 s38, 0
    s_cselect_b32 s54, s8, s14
    s_cselect_b32 s55, s9, s15
    s_mov_b32 s64, s54
    s_and_b32 s65, s55, 0xffff
    s_mov_b32 s66, 401408
    s_mov_b32 s67, 0x00020000
    s_mul_i32 s54, s37, 98
    v_add_u32 v8, s54, v0
    v_lshlrev_b32 v8, 7, v8
    v_cmp_gt_u32 vcc, 98, v0
    v_mov_b32 v9, 0x7f000000
    s_nop 0
    v_cndmask_b32 v9, v9, v8, vcc
    s_add_u32 s54, s44, 0
    s_mov_b32 m0, s54
    v_add_u32 v8, 0, v7
    buffer_load_dwordx4 v8, s[28:31], 0 offen lds
    s_add_u32 s54, s44, 1024
    s_mov_b32 m0, s54
    v_add_u32 v8, 1024, v7
    buffer_load_dwordx4 v8, s[28:31], 0 offen lds
    s_add_u32 s54, s44, 2048
    s_mov_b32 m0, s54
    v_add_u32 v8, 2048, v7
    buffer_load_dwordx4 v8, s[28:31], 0 offen lds
    s_add_u32 s54, s44, 3072
    s_mov_b32 m0, s54
    v_add_u32 v8, 3072, v7
    buffer_load_dwordx4 v8, s[28:31], 0 offen lds
    buffer_load_dwordx2 v[232:233], v10, s[24:27], 0 offen offset:0
    buffer_load_dwordx2 v[234:235], v10, s[24:27], 0 offen offset:256
    buffer_load_dwordx2 v[236:237], v10, s[24:27], 0 offen offset:1024
    buffer_load_dwordx2 v[238:239], v10, s[24:27], 0 offen offset:1280
    s_add_u32 s54, s44, 32768
    s_mov_b32 m0, s54
    v_add_u32 v8, 0, v7
    buffer_load_dwordx4 v8, s[32:35], 0 offen lds
    s_add_u32 s54, s44, 33792
    s_mov_b32 m0, s54
    v_add_u32 v8, 1024, v7
    buffer_load_dwordx4 v8, s[32:35], 0 offen lds
    s_add_u32 s54, s44, 34816
    s_mov_b32 m0, s54
    v_add_u32 v8, 2048, v7
    buffer_load_dwordx4 v8, s[32:35], 0 offen lds
    s_add_u32 s54, s44, 35840
    s_mov_b32 m0, s54
    v_add_u32 v8, 3072, v7
    buffer_load_dwordx4 v8, s[32:35], 0 offen lds
    v_lshlrev_b32 v5, 2, v4
    v_sub_u32 v5, v3, v5
    v_mov_b32 v6, 0xff800000
    s_cmp_eq_u32 s42, 0
    s_cselect_b32 s57, s40, 100
    s_cmp_lt_u32 s57, 8
    s_cselect_b32 s58, 0xff800000, 0
    v_mov_b32 v8, s58
    v_cmp_le_i32 vcc, 0, v5
    s_nop 1
    v_cndmask_b32 v16, v8, v6, vcc
    v_cndmask_b32 v144, v6, 0, vcc
    v_cmp_le_i32 vcc, 1, v5
    s_nop 1
    v_cndmask_b32 v17, v8, v6, vcc
    v_cndmask_b32 v145, v6, 0, vcc
    v_cmp_le_i32 vcc, 2, v5
    s_nop 1
    v_cndmask_b32 v18, v8, v6, vcc
    v_cndmask_b32 v146, v6, 0, vcc
    v_cmp_le_i32 vcc, 3, v5
    s_nop 1
    v_cndmask_b32 v19, v8, v6, vcc
    v_cndmask_b32 v147, v6, 0, vcc
    v_cmp_le_i32 vcc, 8, v5
    s_nop 1
    v_cndmask_b32 v20, v8, v6, vcc
    v_cndmask_b32 v148, v6, 0, vcc
    v_cmp_le_i32 vcc, 9, v5
    s_nop 1
    v_cndmask_b32 v21, v8, v6, vcc
    v_cndmask_b32 v149, v6, 0, vcc
    v_cmp_le_i32 vcc, 10, v5
    s_nop 1
    v_cndmask_b32 v22, v8, v6, vcc
    v_cndmask_b32 v150, v6, 0, vcc
    v_cmp_le_i32 vcc, 11, v5
    s_nop 1
    v_cndmask_b32 v23, v8, v6, vcc
    v_cndmask_b32 v151, v6, 0, vcc
    v_cmp_le_i32 vcc, 16, v5
    s_nop 1
    v_cndmask_b32 v24, v8, v6, vcc
    v_cndmask_b32 v152, v6, 0, vcc
    v_cmp_le_i32 vcc, 17, v5
    s_nop 1
    v_cndmask_b32 v25, v8, v6, vcc
    v_cndmask_b32 v153, v6, 0, vcc
    v_cmp_le_i32 vcc, 18, v5
    s_nop 1
    v_cndmask_b32 v26, v8, v6, vcc
    v_cndmask_b32 v154, v6, 0, vcc
    v_cmp_le_i32 vcc, 19, v5
    s_nop 1
    v_cndmask_b32 v27, v8, v6, vcc
    v_cndmask_b32 v155, v6, 0, vcc
    v_cmp_le_i32 vcc, 24, v5
    s_nop 1
    v_cndmask_b32 v28, v8, v6, vcc
    v_cndmask_b32 v156, v6, 0, vcc
    v_cmp_le_i32 vcc, 25, v5
    s_nop 1
    v_cndmask_b32 v29, v8, v6, vcc
    v_cndmask_b32 v157, v6, 0, vcc
    v_cmp_le_i32 vcc, 26, v5
    s_nop 1
    v_cndmask_b32 v30, v8, v6, vcc
    v_cndmask_b32 v158, v6, 0, vcc
    v_cmp_le_i32 vcc, 27, v5
    s_nop 1
    v_cndmask_b32 v31, v8, v6, vcc
    v_cndmask_b32 v159, v6, 0, vcc
    s_cmp_lt_u32 s57, 7
    s_cselect_b32 s58, 0xff800000, 0
    v_mov_b32 v32, s58
    v_mov_b32 v33, v32
    v_mov_b32 v34, v32
    v_mov_b32 v35, v32
    v_mov_b32 v36, v32
    v_mov_b32 v37, v32
    v_mov_b32 v38, v32
    v_mov_b32 v39, v32
    v_mov_b32 v40, v32
    v_mov_b32 v41, v32
    v_mov_b32 v42, v32
    v_mov_b32 v43, v32
    v_mov_b32 v44, v32
    v_mov_b32 v45, v32
    v_mov_b32 v46, v32
    v_mov_b32 v47, v32
    s_cmp_lt_u32 s57, 6
    s_cselect_b32 s58, 0xff800000, 0
    v_mov_b32 v48, s58
    v_mov_b32 v49, v48
    v_mov_b32 v50, v48
    v_mov_b32 v51, v48
    v_mov_b32 v52, v48
    v_mov_b32 v53, v48
    v_mov_b32 v54, v48
    v_mov_b32 v55, v48
    v_mov_b32 v56, v48
    v_mov_b32 v57, v48
    v_mov_b32 v58, v48
    v_mov_b32 v59, v48
    v_mov_b32 v60, v48
    v_mov_b32 v61, v48
    v_mov_b32 v62, v48
    v_mov_b32 v63, v48
    s_cmp_lt_u32 s57, 5
    s_cselect_b32 s58, 0xff800000, 0
    v_mov_b32 v64, s58
    v_mov_b32 v65, v64
    v_mov_b32 v66, v64
    v_mov_b32 v67, v64
    v_mov_b32 v68, v64
    v_mov_b32 v69, v64
    v_mov_b32 v70, v64
    v_mov_b32 v71, v64
    v_mov_b32 v72, v64
    v_mov_b32 v73, v64
    v_mov_b32 v74, v64
    v_mov_b32 v75, v64
    v_mov_b32 v76, v64
    v_mov_b32 v77, v64
    v_mov_b32 v78, v64
    v_mov_b32 v79, v64
    s_cmp_lt_u32 s57, 4
    s_cselect_b32 s58, 0xff800000, 0
    v_mov_b32 v80, s58
    v_mov_b32 v81, v80
    v_mov_b32 v82, v80
    v_mov_b32 v83, v80
    v_mov_b32 v84, v80
    v_mov_b32 v85, v80
    v_mov_b32 v86, v80
    v_mov_b32 v87, v80
    v_mov_b32 v88, v80
    v_mov_b32 v89, v80
    v_mov_b32 v90, v80
    v_mov_b32 v91, v80
    v_mov_b32 v92, v80
    v_mov_b32 v93, v80
    v_mov_b32 v94, v80
    v_mov_b32 v95, v80
    s_cmp_lt_u32 s57, 3
    s_cselect_b32 s58, 0xff800000, 0
    v_mov_b32 v96, s58
    v_mov_b32 v97, v96
    v_mov_b32 v98, v96
    v_mov_b32 v99, v96
    v_mov_b32 v100, v96
    v_mov_b32 v101, v96
    v_mov_b32 v102, v96
    v_mov_b32 v103, v96
    v_mov_b32 v104, v96
    v_mov_b32 v105, v96
    v_mov_b32 v106, v96
    v_mov_b32 v107, v96
    v_mov_b32 v108, v96
    v_mov_b32 v109, v96
    v_mov_b32 v110, v96
    v_mov_b32 v111, v96
    s_cmp_lt_u32 s57, 2
    s_cselect_b32 s58, 0xff800000, 0
    v_mov_b32 v112, s58
    v_mov_b32 v113, v112
    v_mov_b32 v114, v112
    v_mov_b32 v115, v112
    v_mov_b32 v116, v112
    v_mov_b32 v117, v112
    v_mov_b32 v118, v112
    v_mov_b32 v119, v112
    v_mov_b32 v120, v112
    v_mov_b32 v121, v112
    v_mov_b32 v122, v112
    v_mov_b32 v123, v112
    v_mov_b32 v124, v112
    v_mov_b32 v125, v112
    v_mov_b32 v126, v112
    v_mov_b32 v127, v112
    s_cmp_lt_u32 s57, 1
    s_cselect_b32 s58, 0xff800000, 0
    v_mov_b32 v128, s58
    v_mov_b32 v129, v128
    v_mov_b32 v130, v128
    v_mov_b32 v131, v128
    v_mov_b32 v132, v128
    v_mov_b32 v133, v128
    v_mov_b32 v134, v128
    v_mov_b32 v135, v128
    v_mov_b32 v136, v128
    v_mov_b32 v137, v128
    v_mov_b32 v138, v128
    v_mov_b32 v139, v128
    v_mov_b32 v140, v128
    v_mov_b32 v141, v128
    v_mov_b32 v142, v128
    v_mov_b32 v143, v128
    s_waitcnt vmcnt(4)
    s_barrier
    buffer_load_dword v9, v9, s[64:67], 0 offen
    buffer_load_dword v8, v11, s[60:63], 0 offen offset:0
    buffer_load_dword v8, v11, s[60:63], 0 offen offset:256
    buffer_load_dword v8, v11, s[60:63], 0 offen offset:512
    buffer_load_dword v8, v11, s[60:63], 0 offen offset:768
    ds_read_b64 v[160:161], v12 offset:0
    ds_read_b64 v[162:163], v12 offset:256
    ds_read_b64 v[164:165], v12 offset:1024
    ds_read_b64 v[166:167], v12 offset:1280
    ds_read_b64 v[168:169], v12 offset:2048
    ds_read_b64 v[170:171], v12 offset:2304
    ds_read_b64 v[172:173], v12 offset:3072
    ds_read_b64 v[174:175], v12 offset:3328
    ds_read_b64 v[176:177], v12 offset:4096
    ds_read_b64 v[178:179], v12 offset:4352
    ds_read_b64 v[180:181], v12 offset:5120
    ds_read_b64 v[182:183], v12 offset:5376
    ds_read_b64 v[184:185], v12 offset:6144
    ds_read_b64 v[186:187], v12 offset:6400
    s_waitcnt lgkmcnt(12)
    v_mfma_f32_32x32x16_bf16 v[16:31], v[160:163], v[232:235], v[16:31]
    ds_read_b64 v[188:189], v12 offset:7168
    ds_read_b64 v[190:191], v12 offset:7424
    s_waitcnt lgkmcnt(12)
    v_mfma_f32_32x32x16_bf16 v[16:31], v[164:167], v[236:239], v[16:31]
    ds_read_b64 v[192:193], v12 offset:8192
    ds_read_b64 v[194:195], v12 offset:8448
    s_waitcnt lgkmcnt(12)
    v_mfma_f32_32x32x16_bf16 v[32:47], v[168:171], v[232:235], v[32:47]
    ds_read_b64 v[196:197], v12 offset:9216
    ds_read_b64 v[198:199], v12 offset:9472
    s_waitcnt lgkmcnt(12)
    v_mfma_f32_32x32x16_bf16 v[32:47], v[172:175], v[236:239], v[32:47]
    ds_read_b64 v[200:201], v12 offset:10240
    ds_read_b64 v[202:203], v12 offset:10496
    s_waitcnt lgkmcnt(12)
    v_mfma_f32_32x32x16_bf16 v[48:63], v[176:179], v[232:235], v[48:63]
    ds_read_b64 v[204:205], v12 offset:11264
    ds_read_b64 v[206:207], v12 offset:11520
    v_max3_f32 v5, v16, v17, v18
    v_max3_f32 v5, v5, v19, v20
    v_max3_f32 v5, v5, v21, v22
    v_max_f32 v5, v5, v23
    s_waitcnt lgkmcnt(12)
    v_mfma_f32_32x32x16_bf16 v[48:63], v[180:183], v[236:239], v[48:63]
    ds_read_b64 v[208:209], v12 offset:12288
    ds_read_b64 v[210:211], v12 offset:12544
    v_max3_f32 v6, v24, v25, v26
    v_max3_f32 v6, v6, v27, v28
    v_max3_f32 v6, v6, v29, v30
    v_max_f32 v6, v6, v31
    s_waitcnt lgkmcnt(12)
    v_mfma_f32_32x32x16_bf16 v[64:79], v[184:187], v[232:235], v[64:79]
    ds_read_b64 v[212:213], v12 offset:13312
    ds_read_b64 v[214:215], v12 offset:13568
    v_max3_f32 v5, v5, v32, v33
    v_max3_f32 v5, v5, v34, v35
    v_max3_f32 v5, v5, v36, v37
    v_max3_f32 v5, v5, v38, v39
    s_waitcnt lgkmcnt(12)
    v_mfma_f32_32x32x16_bf16 v[64:79], v[188:191], v[236:239], v[64:79]
    ds_read_b64 v[216:217], v12 offset:14336
    ds_read_b64 v[218:219], v12 offset:14592
    v_max3_f32 v6, v6, v40, v41
    v_max3_f32 v6, v6, v42, v43
    v_max3_f32 v6, v6, v44, v45
    v_max3_f32 v6, v6, v46, v47
    s_waitcnt lgkmcnt(12)
    v_mfma_f32_32x32x16_bf16 v[80:95], v[192:195], v[232:235], v[80:95]
    ds_read_b64 v[220:221], v12 offset:15360
    ds_read_b64 v[222:223], v12 offset:15616
    v_max3_f32 v5, v5, v48, v49
    v_max3_f32 v5, v5, v50, v51
    v_max3_f32 v5, v5, v52, v53
    v_max3_f32 v5, v5, v54, v55
    s_waitcnt lgkmcnt(12)
    v_mfma_f32_32x32x16_bf16 v[80:95], v[196:199], v[236:239], v[80:95]
    ds_read_b64 v[224:225], v12 offset:16384
    ds_read_b64 v[226:227], v12 offset:16640
    v_max3_f32 v6, v6, v56, v57
    v_max3_f32 v6, v6, v58, v59
    v_max3_f32 v6, v6, v60, v61
    v_max3_f32 v6, v6, v62, v63
    s_waitcnt lgkmcnt(12)
    v_mfma_f32_32x32x16_bf16 v[96:111], v[200:203], v[232:235], v[96:111]
    ds_read_b64 v[228:229], v12 offset:17408
    ds_read_b64 v[230:231], v12 offset:17664
    v_max3_f32 v5, v5, v64, v65
    v_max3_f32 v5, v5, v66, v67
    v_max3_f32 v5, v5, v68, v69
    v_max3_f32 v5, v5, v70, v71
    s_waitcnt lgkmcnt(12)
    v_mfma_f32_32x32x16_bf16 v[96:111], v[204:207], v[236:239], v[96:111]
    v_max3_f32 v6, v6, v72, v73
    v_max3_f32 v6, v6, v74, v75
    v_max3_f32 v6, v6, v76, v77
    v_max3_f32 v6, v6, v78, v79
    s_waitcnt lgkmcnt(10)
    v_mfma_f32_32x32x16_bf16 v[112:127], v[208:211], v[232:235], v[112:127]
    v_max3_f32 v5, v5, v80, v81
    v_max3_f32 v5, v5, v82, v83
    v_max3_f32 v5, v5, v84, v85
    v_max3_f32 v5, v5, v86, v87
    s_waitcnt lgkmcnt(8)
    v_mfma_f32_32x32x16_bf16 v[112:127], v[212:215], v[236:239], v[112:127]
    v_max3_f32 v6, v6, v88, v89
    v_max3_f32 v6, v6, v90, v91
    v_max3_f32 v6, v6, v92, v93
    v_max3_f32 v6, v6, v94, v95
    s_waitcnt lgkmcnt(6)
    v_mfma_f32_32x32x16_bf16 v[128:143], v[216:219], v[232:235], v[128:143]
    v_max3_f32 v5, v5, v96, v97
    v_max3_f32 v5, v5, v98, v99
    v_max3_f32 v5, v5, v100, v101
    v_max3_f32 v5, v5, v102, v103
    s_waitcnt lgkmcnt(4)
    v_mfma_f32_32x32x16_bf16 v[128:143], v[220:223], v[236:239], v[128:143]
    v_max3_f32 v6, v6, v104, v105
    v_max3_f32 v6, v6, v106, v107
    v_max3_f32 v6, v6, v108, v109
    v_max3_f32 v6, v6, v110, v111
    s_waitcnt lgkmcnt(2)
    v_mfma_f32_32x32x16_bf16 v[144:159], v[224:227], v[232:235], v[144:159]
    v_max3_f32 v5, v5, v112, v113
    v_max3_f32 v5, v5, v114, v115
    v_max3_f32 v5, v5, v116, v117
    v_max3_f32 v5, v5, v118, v119
    s_waitcnt lgkmcnt(0)
    v_mfma_f32_32x32x16_bf16 v[144:159], v[228:231], v[236:239], v[144:159]
    v_max3_f32 v6, v6, v120, v121
    v_max3_f32 v6, v6, v122, v123
    v_max3_f32 v6, v6, v124, v125
    v_max3_f32 v6, v6, v126, v127
    s_waitcnt vmcnt(5)
    s_barrier
    ds_read_b64_tr_b16 v[160:161], v13 offset:0
    ds_read_b64_tr_b16 v[162:163], v14 offset:0
    ds_read_b64_tr_b16 v[164:165], v15 offset:0
    ds_read_b64_tr_b16 v[166:167], v1 offset:0
    ds_read_b64_tr_b16 v[168:169], v13 offset:2048
    ds_read_b64_tr_b16 v[170:171], v14 offset:2048
    ds_read_b64_tr_b16 v[172:173], v15 offset:2048
    ds_read_b64_tr_b16 v[174:175], v1 offset:2048
    ds_read_b64_tr_b16 v[176:177], v13 offset:4096
    ds_read_b64_tr_b16 v[178:179], v14 offset:4096
    ds_read_b64_tr_b16 v[180:181], v15 offset:4096
    ds_read_b64_tr_b16 v[182:183], v1 offset:4096
    v_max3_f32 v5, v5, v128, v129
    v_max3_f32 v5, v5, v130, v131
    v_max3_f32 v5, v5, v132, v133
    v_max3_f32 v5, v5, v134, v135
    v_max3_f32 v6, v6, v136, v137
    v_max3_f32 v6, v6, v138, v139
    v_max3_f32 v6, v6, v140, v141
    v_max3_f32 v6, v6, v142, v143
    v_max3_f32 v5, v5, v144, v145
    v_max3_f32 v5, v5, v146, v147
    v_max3_f32 v5, v5, v148, v149
    v_max3_f32 v5, v5, v150, v151
    v_max3_f32 v6, v6, v152, v153
    v_max3_f32 v6, v6, v154, v155
    v_max3_f32 v6, v6, v156, v157
    v_max3_f32 v6, v6, v158, v159
    v_max_f32 v5, v5, v6
    v_mov_b32 v7, v5
    s_nop 1
    v_permlane32_swap_b32 v7, v5
    v_max_f32 v5, v5, v7
    v_sub_f32 v16, v16, v5
    v_sub_f32 v17, v17, v5
    v_sub_f32 v18, v18, v5
    v_sub_f32 v19, v19, v5
    v_sub_f32 v20, v20, v5
    v_sub_f32 v21, v21, v5
    v_sub_f32 v22, v22, v5
    v_sub_f32 v23, v23, v5
    v_exp_f32 v16, v16
    v_exp_f32 v17, v17
    v_exp_f32 v18, v18
    v_exp_f32 v19, v19
    v_exp_f32 v20, v20
    v_exp_f32 v21, v21
    v_exp_f32 v22, v22
    v_exp_f32 v23, v23
    v_cvt_pk_bf16_f32 v16, v16, v17
    v_cvt_pk_bf16_f32 v17, v18, v19
    v_cvt_pk_bf16_f32 v18, v20, v21
    v_cvt_pk_bf16_f32 v19, v22, v23
    s_waitcnt lgkmcnt(10)
    s_nop 0
    v_mfma_f32_32x32x16_bf16 v[240:255], v[160:163], v[16:19], 0
    ds_read_b64_tr_b16 v[184:185], v13 offset:6144
    ds_read_b64_tr_b16 v[186:187], v14 offset:6144
    v_sub_f32 v24, v24, v5
    v_sub_f32 v25, v25, v5
    v_sub_f32 v26, v26, v5
    v_sub_f32 v27, v27, v5
    v_sub_f32 v28, v28, v5
    v_sub_f32 v29, v29, v5
    v_sub_f32 v30, v30, v5
    v_sub_f32 v31, v31, v5
    v_exp_f32 v24, v24
    v_exp_f32 v25, v25
    v_exp_f32 v26, v26
    v_exp_f32 v27, v27
    v_exp_f32 v28, v28
    v_exp_f32 v29, v29
    v_exp_f32 v30, v30
    v_exp_f32 v31, v31
    v_cvt_pk_bf16_f32 v24, v24, v25
    v_cvt_pk_bf16_f32 v25, v26, v27
    v_cvt_pk_bf16_f32 v26, v28, v29
    v_cvt_pk_bf16_f32 v27, v30, v31
    s_waitcnt lgkmcnt(10)
    s_nop 0
    v_mfma_f32_32x32x16_bf16 v[240:255], v[164:167], v[24:27], v[240:255]
    ds_read_b64_tr_b16 v[188:189], v15 offset:6144
    ds_read_b64_tr_b16 v[190:191], v1 offset:6144
    v_sub_f32 v32, v32, v5
    v_sub_f32 v33, v33, v5
    v_sub_f32 v34, v34, v5
    v_sub_f32 v35, v35, v5
    v_sub_f32 v36, v36, v5
    v_sub_f32 v37, v37, v5
    v_sub_f32 v38, v38, v5
    v_sub_f32 v39, v39, v5
    v_exp_f32 v32, v32
    v_exp_f32 v33, v33
    v_exp_f32 v34, v34
    v_exp_f32 v35, v35
    v_exp_f32 v36, v36
    v_exp_f32 v37, v37
    v_exp_f32 v38, v38
    v_exp_f32 v39, v39
    v_cvt_pk_bf16_f32 v32, v32, v33
    v_cvt_pk_bf16_f32 v33, v34, v35
    v_cvt_pk_bf16_f32 v34, v36, v37
    v_cvt_pk_bf16_f32 v35, v38, v39
    s_waitcnt lgkmcnt(10)
    s_nop 0
    v_mfma_f32_32x32x16_bf16 v[240:255], v[168:171], v[32:35], v[240:255]
    ds_read_b64_tr_b16 v[192:193], v13 offset:8192
    ds_read_b64_tr_b16 v[194:195], v14 offset:8192
    v_sub_f32 v40, v40, v5
    v_sub_f32 v41, v41, v5
    v_sub_f32 v42, v42, v5
    v_sub_f32 v43, v43, v5
    v_sub_f32 v44, v44, v5
    v_sub_f32 v45, v45, v5
    v_sub_f32 v46, v46, v5
    v_sub_f32 v47, v47, v5
    v_exp_f32 v40, v40
    v_exp_f32 v41, v41
    v_exp_f32 v42, v42
    v_exp_f32 v43, v43
    v_exp_f32 v44, v44
    v_exp_f32 v45, v45
    v_exp_f32 v46, v46
    v_exp_f32 v47, v47
    v_cvt_pk_bf16_f32 v40, v40, v41
    v_cvt_pk_bf16_f32 v41, v42, v43
    v_cvt_pk_bf16_f32 v42, v44, v45
    v_cvt_pk_bf16_f32 v43, v46, v47
    s_waitcnt lgkmcnt(10)
    s_nop 0
    v_mfma_f32_32x32x16_bf16 v[240:255], v[172:175], v[40:43], v[240:255]
    ds_read_b64_tr_b16 v[196:197], v15 offset:8192
    ds_read_b64_tr_b16 v[198:199], v1 offset:8192
    v_sub_f32 v48, v48, v5
    v_sub_f32 v49, v49, v5
    v_sub_f32 v50, v50, v5
    v_sub_f32 v51, v51, v5
    v_sub_f32 v52, v52, v5
    v_sub_f32 v53, v53, v5
    v_sub_f32 v54, v54, v5
    v_sub_f32 v55, v55, v5
    v_exp_f32 v48, v48
    v_exp_f32 v49, v49
    v_exp_f32 v50, v50
    v_exp_f32 v51, v51
    v_exp_f32 v52, v52
    v_exp_f32 v53, v53
    v_exp_f32 v54, v54
    v_exp_f32 v55, v55
    v_cvt_pk_bf16_f32 v48, v48, v49
    v_cvt_pk_bf16_f32 v49, v50, v51
    v_cvt_pk_bf16_f32 v50, v52, v53
    v_cvt_pk_bf16_f32 v51, v54, v55
    s_waitcnt lgkmcnt(10)
    s_nop 0
    v_mfma_f32_32x32x16_bf16 v[240:255], v[176:179], v[48:51], v[240:255]
    ds_read_b64_tr_b16 v[200:201], v13 offset:10240
    ds_read_b64_tr_b16 v[202:203], v14 offset:10240
    v_sub_f32 v56, v56, v5
    v_sub_f32 v57, v57, v5
    v_sub_f32 v58, v58, v5
    v_sub_f32 v59, v59, v5
    v_sub_f32 v60, v60, v5
    v_sub_f32 v61, v61, v5
    v_sub_f32 v62, v62, v5
    v_sub_f32 v63, v63, v5
    v_exp_f32 v56, v56
    v_exp_f32 v57, v57
    v_exp_f32 v58, v58
    v_exp_f32 v59, v59
    v_exp_f32 v60, v60
    v_exp_f32 v61, v61
    v_exp_f32 v62, v62
    v_exp_f32 v63, v63
    v_cvt_pk_bf16_f32 v56, v56, v57
    v_cvt_pk_bf16_f32 v57, v58, v59
    v_cvt_pk_bf16_f32 v58, v60, v61
    v_cvt_pk_bf16_f32 v59, v62, v63
    s_waitcnt lgkmcnt(10)
    s_nop 0
    v_mfma_f32_32x32x16_bf16 v[240:255], v[180:183], v[56:59], v[240:255]
    ds_read_b64_tr_b16 v[204:205], v15 offset:10240
    ds_read_b64_tr_b16 v[206:207], v1 offset:10240
    v_sub_f32 v64, v64, v5
    v_sub_f32 v65, v65, v5
    v_sub_f32 v66, v66, v5
    v_sub_f32 v67, v67, v5
    v_sub_f32 v68, v68, v5
    v_sub_f32 v69, v69, v5
    v_sub_f32 v70, v70, v5
    v_sub_f32 v71, v71, v5
    v_exp_f32 v64, v64
    v_exp_f32 v65, v65
    v_exp_f32 v66, v66
    v_exp_f32 v67, v67
    v_exp_f32 v68, v68
    v_exp_f32 v69, v69
    v_exp_f32 v70, v70
    v_exp_f32 v71, v71
    v_cvt_pk_bf16_f32 v64, v64, v65
    v_cvt_pk_bf16_f32 v65, v66, v67
    v_cvt_pk_bf16_f32 v66, v68, v69
    v_cvt_pk_bf16_f32 v67, v70, v71
    s_waitcnt lgkmcnt(10)
    s_nop 0
    v_mfma_f32_32x32x16_bf16 v[240:255], v[184:187], v[64:67], v[240:255]
    ds_read_b64_tr_b16 v[208:209], v13 offset:12288
    ds_read_b64_tr_b16 v[210:211], v14 offset:12288
    v_sub_f32 v72, v72, v5
    v_sub_f32 v73, v73, v5
    v_sub_f32 v74, v74, v5
    v_sub_f32 v75, v75, v5
    v_sub_f32 v76, v76, v5
    v_sub_f32 v77, v77, v5
    v_sub_f32 v78, v78, v5
    v_sub_f32 v79, v79, v5
    v_exp_f32 v72, v72
    v_exp_f32 v73, v73
    v_exp_f32 v74, v74
    v_exp_f32 v75, v75
    v_exp_f32 v76, v76
    v_exp_f32 v77, v77
    v_exp_f32 v78, v78
    v_exp_f32 v79, v79
    v_cvt_pk_bf16_f32 v72, v72, v73
    v_cvt_pk_bf16_f32 v73, v74, v75
    v_cvt_pk_bf16_f32 v74, v76, v77
    v_cvt_pk_bf16_f32 v75, v78, v79
    s_waitcnt lgkmcnt(10)
    s_nop 0
    v_mfma_f32_32x32x16_bf16 v[240:255], v[188:191], v[72:75], v[240:255]
    ds_read_b64_tr_b16 v[212:213], v15 offset:12288
    ds_read_b64_tr_b16 v[214:215], v1 offset:12288
    v_sub_f32 v80, v80, v5
    v_sub_f32 v81, v81, v5
    v_sub_f32 v82, v82, v5
    v_sub_f32 v83, v83, v5
    v_sub_f32 v84, v84, v5
    v_sub_f32 v85, v85, v5
    v_sub_f32 v86, v86, v5
    v_sub_f32 v87, v87, v5
    v_exp_f32 v80, v80
    v_exp_f32 v81, v81
    v_exp_f32 v82, v82
    v_exp_f32 v83, v83
    v_exp_f32 v84, v84
    v_exp_f32 v85, v85
    v_exp_f32 v86, v86
    v_exp_f32 v87, v87
    v_cvt_pk_bf16_f32 v80, v80, v81
    v_cvt_pk_bf16_f32 v81, v82, v83
    v_cvt_pk_bf16_f32 v82, v84, v85
    v_cvt_pk_bf16_f32 v83, v86, v87
    s_waitcnt lgkmcnt(10)
    s_nop 0
    v_mfma_f32_32x32x16_bf16 v[240:255], v[192:195], v[80:83], v[240:255]
    ds_read_b64_tr_b16 v[216:217], v13 offset:14336
    ds_read_b64_tr_b16 v[218:219], v14 offset:14336
    v_sub_f32 v88, v88, v5
    v_sub_f32 v89, v89, v5
    v_sub_f32 v90, v90, v5
    v_sub_f32 v91, v91, v5
    v_sub_f32 v92, v92, v5
    v_sub_f32 v93, v93, v5
    v_sub_f32 v94, v94, v5
    v_sub_f32 v95, v95, v5
    v_exp_f32 v88, v88
    v_exp_f32 v89, v89
    v_exp_f32 v90, v90
    v_exp_f32 v91, v91
    v_exp_f32 v92, v92
    v_exp_f32 v93, v93
    v_exp_f32 v94, v94
    v_exp_f32 v95, v95
    v_cvt_pk_bf16_f32 v88, v88, v89
    v_cvt_pk_bf16_f32 v89, v90, v91
    v_cvt_pk_bf16_f32 v90, v92, v93
    v_cvt_pk_bf16_f32 v91, v94, v95
    s_waitcnt lgkmcnt(10)
    s_nop 0
    v_mfma_f32_32x32x16_bf16 v[240:255], v[196:199], v[88:91], v[240:255]
    ds_read_b64_tr_b16 v[220:221], v15 offset:14336
    ds_read_b64_tr_b16 v[222:223], v1 offset:14336
    v_sub_f32 v96, v96, v5
    v_sub_f32 v97, v97, v5
    v_sub_f32 v98, v98, v5
    v_sub_f32 v99, v99, v5
    v_sub_f32 v100, v100, v5
    v_sub_f32 v101, v101, v5
    v_sub_f32 v102, v102, v5
    v_sub_f32 v103, v103, v5
    v_exp_f32 v96, v96
    v_exp_f32 v97, v97
    v_exp_f32 v98, v98
    v_exp_f32 v99, v99
    v_exp_f32 v100, v100
    v_exp_f32 v101, v101
    v_exp_f32 v102, v102
    v_exp_f32 v103, v103
    v_cvt_pk_bf16_f32 v96, v96, v97
    v_cvt_pk_bf16_f32 v97, v98, v99
    v_cvt_pk_bf16_f32 v98, v100, v101
    v_cvt_pk_bf16_f32 v99, v102, v103
    s_waitcnt lgkmcnt(10)
    s_nop 0
    v_mfma_f32_32x32x16_bf16 v[240:255], v[200:203], v[96:99], v[240:255]
    ds_read_b64_tr_b16 v[224:225], v13 offset:16384
    ds_read_b64_tr_b16 v[226:227], v14 offset:16384
    v_sub_f32 v104, v104, v5
    v_sub_f32 v105, v105, v5
    v_sub_f32 v106, v106, v5
    v_sub_f32 v107, v107, v5
    v_sub_f32 v108, v108, v5
    v_sub_f32 v109, v109, v5
    v_sub_f32 v110, v110, v5
    v_sub_f32 v111, v111, v5
    v_exp_f32 v104, v104
    v_exp_f32 v105, v105
    v_exp_f32 v106, v106
    v_exp_f32 v107, v107
    v_exp_f32 v108, v108
    v_exp_f32 v109, v109
    v_exp_f32 v110, v110
    v_exp_f32 v111, v111
    v_cvt_pk_bf16_f32 v104, v104, v105
    v_cvt_pk_bf16_f32 v105, v106, v107
    v_cvt_pk_bf16_f32 v106, v108, v109
    v_cvt_pk_bf16_f32 v107, v110, v111
    s_waitcnt lgkmcnt(10)
    s_nop 0
    v_mfma_f32_32x32x16_bf16 v[240:255], v[204:207], v[104:107], v[240:255]
    ds_read_b64_tr_b16 v[228:229], v15 offset:16384
    ds_read_b64_tr_b16 v[230:231], v1 offset:16384
    v_sub_f32 v112, v112, v5
    v_sub_f32 v113, v113, v5
    v_sub_f32 v114, v114, v5
    v_sub_f32 v115, v115, v5
    v_sub_f32 v116, v116, v5
    v_sub_f32 v117, v117, v5
    v_sub_f32 v118, v118, v5
    v_sub_f32 v119, v119, v5
    v_exp_f32 v112, v112
    v_exp_f32 v113, v113
    v_exp_f32 v114, v114
    v_exp_f32 v115, v115
    v_exp_f32 v116, v116
    v_exp_f32 v117, v117
    v_exp_f32 v118, v118
    v_exp_f32 v119, v119
    v_cvt_pk_bf16_f32 v112, v112, v113
    v_cvt_pk_bf16_f32 v113, v114, v115
    v_cvt_pk_bf16_f32 v114, v116, v117
    v_cvt_pk_bf16_f32 v115, v118, v119
    s_waitcnt lgkmcnt(10)
    s_nop 0
    v_mfma_f32_32x32x16_bf16 v[240:255], v[208:211], v[112:115], v[240:255]
    v_sub_f32 v120, v120, v5
    v_sub_f32 v121, v121, v5
    v_sub_f32 v122, v122, v5
    v_sub_f32 v123, v123, v5
    v_sub_f32 v124, v124, v5
    v_sub_f32 v125, v125, v5
    v_sub_f32 v126, v126, v5
    v_sub_f32 v127, v127, v5
    v_exp_f32 v120, v120
    v_exp_f32 v121, v121
    v_exp_f32 v122, v122
    v_exp_f32 v123, v123
    v_exp_f32 v124, v124
    v_exp_f32 v125, v125
    v_exp_f32 v126, v126
    v_exp_f32 v127, v127
    v_cvt_pk_bf16_f32 v120, v120, v121
    v_cvt_pk_bf16_f32 v121, v122, v123
    v_cvt_pk_bf16_f32 v122, v124, v125
    v_cvt_pk_bf16_f32 v123, v126, v127
    s_waitcnt lgkmcnt(8)
    s_nop 0
    v_mfma_f32_32x32x16_bf16 v[240:255], v[212:215], v[120:123], v[240:255]
    v_sub_f32 v128, v128, v5
    v_sub_f32 v129, v129, v5
    v_sub_f32 v130, v130, v5
    v_sub_f32 v131, v131, v5
    v_sub_f32 v132, v132, v5
    v_sub_f32 v133, v133, v5
    v_sub_f32 v134, v134, v5
    v_sub_f32 v135, v135, v5
    v_exp_f32 v128, v128
    v_exp_f32 v129, v129
    v_exp_f32 v130, v130
    v_exp_f32 v131, v131
    v_exp_f32 v132, v132
    v_exp_f32 v133, v133
    v_exp_f32 v134, v134
    v_exp_f32 v135, v135
    v_cvt_pk_bf16_f32 v128, v128, v129
    v_cvt_pk_bf16_f32 v129, v130, v131
    v_cvt_pk_bf16_f32 v130, v132, v133
    v_cvt_pk_bf16_f32 v131, v134, v135
    s_waitcnt lgkmcnt(6)
    s_nop 0
    v_mfma_f32_32x32x16_bf16 v[240:255], v[216:219], v[128:131], v[240:255]
    v_sub_f32 v136, v136, v5
    v_sub_f32 v137, v137, v5
    v_sub_f32 v138, v138, v5
    v_sub_f32 v139, v139, v5
    v_sub_f32 v140, v140, v5
    v_sub_f32 v141, v141, v5
    v_sub_f32 v142, v142, v5
    v_sub_f32 v143, v143, v5
    v_exp_f32 v136, v136
    v_exp_f32 v137, v137
    v_exp_f32 v138, v138
    v_exp_f32 v139, v139
    v_exp_f32 v140, v140
    v_exp_f32 v141, v141
    v_exp_f32 v142, v142
    v_exp_f32 v143, v143
    v_cvt_pk_bf16_f32 v136, v136, v137
    v_cvt_pk_bf16_f32 v137, v138, v139
    v_cvt_pk_bf16_f32 v138, v140, v141
    v_cvt_pk_bf16_f32 v139, v142, v143
    s_waitcnt lgkmcnt(4)
    s_nop 0
    v_mfma_f32_32x32x16_bf16 v[240:255], v[220:223], v[136:139], v[240:255]
    v_sub_f32 v144, v144, v5
    v_sub_f32 v145, v145, v5
    v_sub_f32 v146, v146, v5
    v_sub_f32 v147, v147, v5
    v_sub_f32 v148, v148, v5
    v_sub_f32 v149, v149, v5
    v_sub_f32 v150, v150, v5
    v_sub_f32 v151, v151, v5
    v_exp_f32 v144, v144
    v_exp_f32 v145, v145
    v_exp_f32 v146, v146
    v_exp_f32 v147, v147
    v_exp_f32 v148, v148
    v_exp_f32 v149, v149
    v_exp_f32 v150, v150
    v_exp_f32 v151, v151
    v_cvt_pk_bf16_f32 v144, v144, v145
    v_cvt_pk_bf16_f32 v145, v146, v147
    v_cvt_pk_bf16_f32 v146, v148, v149
    v_cvt_pk_bf16_f32 v147, v150, v151
    s_waitcnt lgkmcnt(2)
    s_nop 0
    v_mfma_f32_32x32x16_bf16 v[240:255], v[224:227], v[144:147], v[240:255]
    v_sub_f32 v152, v152, v5
    v_sub_f32 v153, v153, v5
    v_sub_f32 v154, v154, v5
    v_sub_f32 v155, v155, v5
    v_sub_f32 v156, v156, v5
    v_sub_f32 v157, v157, v5
    v_sub_f32 v158, v158, v5
    v_sub_f32 v159, v159, v5
    v_exp_f32 v152, v152
    v_exp_f32 v153, v153
    v_exp_f32 v154, v154
    v_exp_f32 v155, v155
    v_exp_f32 v156, v156
    v_exp_f32 v157, v157
    v_exp_f32 v158, v158
    v_exp_f32 v159, v159
    v_cvt_pk_bf16_f32 v152, v152, v153
    v_cvt_pk_bf16_f32 v153, v154, v155
    v_cvt_pk_bf16_f32 v154, v156, v157
    v_cvt_pk_bf16_f32 v155, v158, v159
    s_waitcnt lgkmcnt(0)
    s_nop 0
    v_mfma_f32_32x32x16_bf16 v[240:255], v[228:231], v[152:155], v[240:255]
    v_cmp_eq_u32 vcc, 0, v4
    v_mov_b32 v5, 0x7f000000
    s_nop 0
    v_cndmask_b32 v15, v5, v11, vcc
    s_nop 7
    v_mov_b32 v5, v252
    v_mov_b32 v6, v252
    s_nop 1
    v_permlane32_swap_b32 v5, v6
    v_rcp_f32 v6, v6
    s_nop 0
    v_mul_f32 v240, v240, v6
    v_mul_f32 v241, v241, v6
    v_mul_f32 v242, v242, v6
    v_mul_f32 v243, v243, v6
    v_cvt_pk_bf16_f32 v240, v240, v241
    v_cvt_pk_bf16_f32 v241, v242, v243
    buffer_store_dwordx2 v[240:241], v11, s[60:63], 0 offen offset:0
    v_mul_f32 v244, v244, v6
    v_mul_f32 v245, v245, v6
    v_mul_f32 v246, v246, v6
    v_mul_f32 v247, v247, v6
    v_cvt_pk_bf16_f32 v244, v244, v245
    v_cvt_pk_bf16_f32 v245, v246, v247
    buffer_store_dwordx2 v[244:245], v11, s[60:63], 0 offen offset:256
    v_mul_f32 v248, v248, v6
    v_mul_f32 v249, v249, v6
    v_mul_f32 v250, v250, v6
    v_mul_f32 v251, v251, v6
    v_cvt_pk_bf16_f32 v248, v248, v249
    v_cvt_pk_bf16_f32 v249, v250, v251
    buffer_store_dwordx2 v[248:249], v11, s[60:63], 0 offen offset:512
    v_mul_f32 v252, v252, v6
    v_mul_f32 v253, v253, v6
    v_mul_f32 v254, v254, v6
    v_mul_f32 v255, v255, v6
    v_cvt_pk_bf16_f32 v252, v252, v253
    v_cvt_pk_bf16_f32 v253, v254, v255
    buffer_store_dwordx2 v[252:253], v15, s[60:63], 0 offen offset:768
L_end_attn_kernel:
    s_endpgm
.p2align 8
.globl proj_kernel
.type proj_kernel,@function
proj_kernel:
    s_cmp_ge_u32 s2, 224
    s_cbranch_scc1 L_end_proj_kernel
    s_load_dwordx16 s[4:19], s[0:1], 0
    s_load_dwordx2 s[20:21], s[0:1], 64
    v_lshrrev_b32 v1, 6, v0
    v_and_b32 v2, 63, v0
    v_readfirstlane_b32 s40, v1
    s_and_b32 s36, s2, 7
    s_lshr_b32 s37, s2, 3
    s_lshr_b32 s38, s36, 2
    s_and_b32 s36, s36, 3
    s_mul_i32 s39, s37, 37
    s_lshr_b32 s39, s39, 8
    s_mul_i32 s41, s39, 7
    s_sub_u32 s41, s37, s41
    s_mul_i32 s42, s36, 4
    s_add_u32 s42, s42, s39
    s_and_b32 s46, s40, 3
    s_lshl_b32 s43, s42, 3
    s_lshl_b32 s44, s46, 1
    s_add_u32 s43, s43, s44
    s_lshl_b32 s47, s41, 7
    v_and_b32 v3, 15, v2
    v_lshrrev_b32 v4, 4, v2
    v_lshlrev_b32 v6, 4, v2
    s_cmp_ge_u32 s40, 4
    s_cbranch_scc1 L_load_proj_kernel
    s_lshl_b32 s44, s43, 4
    v_add_u32 v5, s44, v3
    v_mul_u32_u24 v7, 1792, v5
    v_lshl_add_u32 v7, v4, 4, v7
    v_add_u32 v7, s47, v7
    s_mov_b32 s48, 28672
    s_lshl_b32 s44, s46, 12
    s_add_u32 s44, s44, 57472
    v_add_u32 v6, s44, v6
    v_and_b32 v10, 1, v4
    v_mul_u32_u24 v10, 28680, v10
    v_lshrrev_b32 v8, 1, v4
    v_lshl_add_u32 v10, v8, 10, v10
    v_lshrrev_b32 v8, 2, v3
    v_lshl_add_u32 v10, v8, 7, v10
    v_and_b32 v12, 3, v2
    v_lshl_add_u32 v10, v12, 4, v10
    v_lshrrev_b32 v8, 1, v8
    v_lshl_add_u32 v10, v8, 6, v10
    v_xor_b32 v12, 64, v10
    s_waitcnt lgkmcnt(0)
    s_mul_i32 s56, s38, 896
    s_add_u32 s52, s16, s56
    s_addc_u32 s53, s17, 0
    s_sub_u32 s57, 3670016, s56
    s_mov_b32 s32, s52
    s_and_b32 s33, s53, 0xffff
    s_mov_b32 s34, s57
    s_mov_b32 s35, 0x00020000
    v_add_u32 v11, 0x10000, v6
    s_barrier
    ds_read_b128 v[16:19], v6 offset:0
    ds_read_b128 v[20:23], v6 offset:2048
    ds_read_b64_tr_b16 v[32:33], v10 offset:0
    ds_read_b64_tr_b16 v[34:35], v10 offset:512
    ds_read_b64_tr_b16 v[36:37], v10 offset:8
    ds_read_b64_tr_b16 v[38:39], v10 offset:520
    ds_read_b64_tr_b16 v[40:41], v12 offset:0
    ds_read_b64_tr_b16 v[42:43], v12 offset:512
    ds_read_b64_tr_b16 v[44:45], v12 offset:8
    ds_read_b64_tr_b16 v[46:47], v12 offset:520
    ds_read_b128 v[24:27], v6 offset:1024
    ds_read_b128 v[28:31], v6 offset:3072
    s_waitcnt lgkmcnt(8)
    v_mfma_f32_16x16x32_bf16 v[64:67], v[32:35], v[16:19], 0
    v_mfma_f32_16x16x32_bf16 v[68:71], v[32:35], v[20:23], 0
    ds_read_b64_tr_b16 v[48:49], v10 offset:2048
    ds_read_b64_tr_b16 v[50:51], v10 offset:2560
    s_waitcnt lgkmcnt(8)
    v_mfma_f32_16x16x32_bf16 v[72:75], v[36:39], v[16:19], 0
    v_mfma_f32_16x16x32_bf16 v[76:79], v[36:39], v[20:23], 0
    ds_read_b64_tr_b16 v[52:53], v10 offset:2056
    ds_read_b64_tr_b16 v[54:55], v10 offset:2568
    s_waitcnt lgkmcnt(8)
    v_mfma_f32_16x16x32_bf16 v[80:83], v[40:43], v[16:19], 0
    v_mfma_f32_16x16x32_bf16 v[84:87], v[40:43], v[20:23], 0
    ds_read_b64_tr_b16 v[56:57], v12 offset:2048
    ds_read_b64_tr_b16 v[58:59], v12 offset:2560
    s_waitcnt lgkmcnt(8)
    v_mfma_f32_16x16x32_bf16 v[88:91], v[44:47], v[16:19], 0
    v_mfma_f32_16x16x32_bf16 v[92:95], v[44:47], v[20:23], 0
    ds_read_b64_tr_b16 v[60:61], v12 offset:2056
    ds_read_b64_tr_b16 v[62:63], v12 offset:2568
    s_waitcnt lgkmcnt(0)
    s_barrier
    ds_read_b128 v[16:19], v6 offset:16384
    ds_read_b128 v[20:23], v6 offset:18432
    v_mfma_f32_16x16x32_bf16 v[64:67], v[48:51], v[24:27], v[64:67]
    v_mfma_f32_16x16x32_bf16 v[68:71], v[48:51], v[28:31], v[68:71]
    ds_read_b64_tr_b16 v[32:33], v10 offset:4096
    ds_read_b64_tr_b16 v[34:35], v10 offset:4608
    v_mfma_f32_16x16x32_bf16 v[72:75], v[52:55], v[24:27], v[72:75]
    v_mfma_f32_16x16x32_bf16 v[76:79], v[52:55], v[28:31], v[76:79]
    ds_read_b64_tr_b16 v[36:37], v10 offset:4104
    ds_read_b64_tr_b16 v[38:39], v10 offset:4616
    v_mfma_f32_16x16x32_bf16 v[80:83], v[56:59], v[24:27], v[80:83]
    v_mfma_f32_16x16x32_bf16 v[84:87], v[56:59], v[28:31], v[84:87]
    ds_read_b64_tr_b16 v[40:41], v12 offset:4096
    ds_read_b64_tr_b16 v[42:43], v12 offset:4608
    v_mfma_f32_16x16x32_bf16 v[88:91], v[60:63], v[24:27], v[88:91]
    v_mfma_f32_16x16x32_bf16 v[92:95], v[60:63], v[28:31], v[92:95]
    ds_read_b64_tr_b16 v[44:45], v12 offset:4104
    ds_read_b64_tr_b16 v[46:47], v12 offset:4616
    ds_read_b128 v[24:27], v6 offset:17408
    ds_read_b128 v[28:31], v6 offset:19456
    s_waitcnt lgkmcnt(8)
    v_mfma_f32_16x16x32_bf16 v[64:67], v[32:35], v[16:19], v[64:67]
    v_mfma_f32_16x16x32_bf16 v[68:71], v[32:35], v[20:23], v[68:71]
    ds_read_b64_tr_b16 v[48:49], v10 offset:6144
    ds_read_b64_tr_b16 v[50:51], v10 offset:6656
    s_waitcnt lgkmcnt(8)
    v_mfma_f32_16x16x32_bf16 v[72:75], v[36:39], v[16:19], v[72:75]
    v_mfma_f32_16x16x32_bf16 v[76:79], v[36:39], v[20:23], v[76:79]
    ds_read_b64_tr_b16 v[52:53], v10 offset:6152
    ds_read_b64_tr_b16 v[54:55], v10 offset:6664
    s_waitcnt lgkmcnt(8)
    v_mfma_f32_16x16x32_bf16 v[80:83], v[40:43], v[16:19], v[80:83]
    v_mfma_f32_16x16x32_bf16 v[84:87], v[40:43], v[20:23], v[84:87]
    ds_read_b64_tr_b16 v[56:57], v12 offset:6144
    ds_read_b64_tr_b16 v[58:59], v12 offset:6656
    s_waitcnt lgkmcnt(8)
    v_mfma_f32_16x16x32_bf16 v[88:91], v[44:47], v[16:19], v[88:91]
    v_mfma_f32_16x16x32_bf16 v[92:95], v[44:47], v[20:23], v[92:95]
    ds_read_b64_tr_b16 v[60:61], v12 offset:6152
    ds_read_b64_tr_b16 v[62:63], v12 offset:6664
    s_waitcnt lgkmcnt(0)
    s_barrier
    ds_read_b128 v[16:19], v6 offset:32768
    ds_read_b128 v[20:23], v6 offset:34816
    v_mfma_f32_16x16x32_bf16 v[64:67], v[48:51], v[24:27], v[64:67]
    v_mfma_f32_16x16x32_bf16 v[68:71], v[48:51], v[28:31], v[68:71]
    ds_read_b64_tr_b16 v[32:33], v10 offset:8192
    ds_read_b64_tr_b16 v[34:35], v10 offset:8704
    v_mfma_f32_16x16x32_bf16 v[72:75], v[52:55], v[24:27], v[72:75]
    v_mfma_f32_16x16x32_bf16 v[76:79], v[52:55], v[28:31], v[76:79]
    ds_read_b64_tr_b16 v[36:37], v10 offset:8200
    ds_read_b64_tr_b16 v[38:39], v10 offset:8712
    v_mfma_f32_16x16x32_bf16 v[80:83], v[56:59], v[24:27], v[80:83]
    v_mfma_f32_16x16x32_bf16 v[84:87], v[56:59], v[28:31], v[84:87]
    ds_read_b64_tr_b16 v[40:41], v12 offset:8192
    ds_read_b64_tr_b16 v[42:43], v12 offset:8704
    v_mfma_f32_16x16x32_bf16 v[88:91], v[60:63], v[24:27], v[88:91]
    v_mfma_f32_16x16x32_bf16 v[92:95], v[60:63], v[28:31], v[92:95]
    ds_read_b64_tr_b16 v[44:45], v12 offset:8200
    ds_read_b64_tr_b16 v[46:47], v12 offset:8712
    ds_read_b128 v[24:27], v6 offset:33792
    ds_read_b128 v[28:31], v6 offset:35840
    s_waitcnt lgkmcnt(8)
    v_mfma_f32_16x16x32_bf16 v[64:67], v[32:35], v[16:19], v[64:67]
    v_mfma_f32_16x16x32_bf16 v[68:71], v[32:35], v[20:23], v[68:71]
    ds_read_b64_tr_b16 v[48:49], v10 offset:10240
    ds_read_b64_tr_b16 v[50:51], v10 offset:10752
    s_waitcnt lgkmcnt(8)
    v_mfma_f32_16x16x32_bf16 v[72:75], v[36:39], v[16:19], v[72:75]
    v_mfma_f32_16x16x32_bf16 v[76:79], v[36:39], v[20:23], v[76:79]
    ds_read_b64_tr_b16 v[52:53], v10 offset:10248
    ds_read_b64_tr_b16 v[54:55], v10 offset:10760
    s_waitcnt lgkmcnt(8)
    v_mfma_f32_16x16x32_bf16 v[80:83], v[40:43], v[16:19], v[80:83]
    v_mfma_f32_16x16x32_bf16 v[84:87], v[40:43], v[20:23], v[84:87]
    ds_read_b64_tr_b16 v[56:57], v12 offset:10240
    ds_read_b64_tr_b16 v[58:59], v12 offset:10752
    s_waitcnt lgkmcnt(8)
    v_mfma_f32_16x16x32_bf16 v[88:91], v[44:47], v[16:19], v[88:91]
    v_mfma_f32_16x16x32_bf16 v[92:95], v[44:47], v[20:23], v[92:95]
    ds_read_b64_tr_b16 v[60:61], v12 offset:10248
    ds_read_b64_tr_b16 v[62:63], v12 offset:10760
    s_waitcnt lgkmcnt(0)
    s_barrier
    ds_read_b128 v[16:19], v6 offset:49152
    ds_read_b128 v[20:23], v6 offset:51200
    v_mfma_f32_16x16x32_bf16 v[64:67], v[48:51], v[24:27], v[64:67]
    v_mfma_f32_16x16x32_bf16 v[68:71], v[48:51], v[28:31], v[68:71]
    ds_read_b64_tr_b16 v[32:33], v10 offset:12288
    ds_read_b64_tr_b16 v[34:35], v10 offset:12800
    v_mfma_f32_16x16x32_bf16 v[72:75], v[52:55], v[24:27], v[72:75]
    v_mfma_f32_16x16x32_bf16 v[76:79], v[52:55], v[28:31], v[76:79]
    ds_read_b64_tr_b16 v[36:37], v10 offset:12296
    ds_read_b64_tr_b16 v[38:39], v10 offset:12808
    v_mfma_f32_16x16x32_bf16 v[80:83], v[56:59], v[24:27], v[80:83]
    v_mfma_f32_16x16x32_bf16 v[84:87], v[56:59], v[28:31], v[84:87]
    ds_read_b64_tr_b16 v[40:41], v12 offset:12288
    ds_read_b64_tr_b16 v[42:43], v12 offset:12800
    v_mfma_f32_16x16x32_bf16 v[88:91], v[60:63], v[24:27], v[88:91]
    v_mfma_f32_16x16x32_bf16 v[92:95], v[60:63], v[28:31], v[92:95]
    ds_read_b64_tr_b16 v[44:45], v12 offset:12296
    ds_read_b64_tr_b16 v[46:47], v12 offset:12808
    ds_read_b128 v[24:27], v6 offset:50176
    ds_read_b128 v[28:31], v6 offset:52224
    s_waitcnt lgkmcnt(8)
    v_mfma_f32_16x16x32_bf16 v[64:67], v[32:35], v[16:19], v[64:67]
    v_mfma_f32_16x16x32_bf16 v[68:71], v[32:35], v[20:23], v[68:71]
    ds_read_b64_tr_b16 v[48:49], v10 offset:14336
    ds_read_b64_tr_b16 v[50:51], v10 offset:14848
    s_waitcnt lgkmcnt(8)
    v_mfma_f32_16x16x32_bf16 v[72:75], v[36:39], v[16:19], v[72:75]
    v_mfma_f32_16x16x32_bf16 v[76:79], v[36:39], v[20:23], v[76:79]
    ds_read_b64_tr_b16 v[52:53], v10 offset:14344
    ds_read_b64_tr_b16 v[54:55], v10 offset:14856
    s_waitcnt lgkmcnt(8)
    v_mfma_f32_16x16x32_bf16 v[80:83], v[40:43], v[16:19], v[80:83]
    v_mfma_f32_16x16x32_bf16 v[84:87], v[40:43], v[20:23], v[84:87]
    ds_read_b64_tr_b16 v[56:57], v12 offset:14336
    ds_read_b64_tr_b16 v[58:59], v12 offset:14848
    s_waitcnt lgkmcnt(8)
    v_mfma_f32_16x16x32_bf16 v[88:91], v[44:47], v[16:19], v[88:91]
    v_mfma_f32_16x16x32_bf16 v[92:95], v[44:47], v[20:23], v[92:95]
    ds_read_b64_tr_b16 v[60:61], v12 offset:14344
    ds_read_b64_tr_b16 v[62:63], v12 offset:14856
    s_waitcnt lgkmcnt(0)
    s_barrier
    ds_read_b128 v[16:19], v11 offset:0
    ds_read_b128 v[20:23], v11 offset:2048
    v_mfma_f32_16x16x32_bf16 v[64:67], v[48:51], v[24:27], v[64:67]
    v_mfma_f32_16x16x32_bf16 v[68:71], v[48:51], v[28:31], v[68:71]
    ds_read_b64_tr_b16 v[32:33], v10 offset:16384
    ds_read_b64_tr_b16 v[34:35], v10 offset:16896
    v_mfma_f32_16x16x32_bf16 v[72:75], v[52:55], v[24:27], v[72:75]
    v_mfma_f32_16x16x32_bf16 v[76:79], v[52:55], v[28:31], v[76:79]
    ds_read_b64_tr_b16 v[36:37], v10 offset:16392
    ds_read_b64_tr_b16 v[38:39], v10 offset:16904
    v_mfma_f32_16x16x32_bf16 v[80:83], v[56:59], v[24:27], v[80:83]
    v_mfma_f32_16x16x32_bf16 v[84:87], v[56:59], v[28:31], v[84:87]
    ds_read_b64_tr_b16 v[40:41], v12 offset:16384
    ds_read_b64_tr_b16 v[42:43], v12 offset:16896
    v_mfma_f32_16x16x32_bf16 v[88:91], v[60:63], v[24:27], v[88:91]
    v_mfma_f32_16x16x32_bf16 v[92:95], v[60:63], v[28:31], v[92:95]
    ds_read_b64_tr_b16 v[44:45], v12 offset:16392
    ds_read_b64_tr_b16 v[46:47], v12 offset:16904
    ds_read_b128 v[24:27], v11 offset:1024
    ds_read_b128 v[28:31], v11 offset:3072
    s_waitcnt lgkmcnt(8)
    v_mfma_f32_16x16x32_bf16 v[64:67], v[32:35], v[16:19], v[64:67]
    v_mfma_f32_16x16x32_bf16 v[68:71], v[32:35], v[20:23], v[68:71]
    ds_read_b64_tr_b16 v[48:49], v10 offset:18432
    ds_read_b64_tr_b16 v[50:51], v10 offset:18944
    s_waitcnt lgkmcnt(8)
    v_mfma_f32_16x16x32_bf16 v[72:75], v[36:39], v[16:19], v[72:75]
    v_mfma_f32_16x16x32_bf16 v[76:79], v[36:39], v[20:23], v[76:79]
    ds_read_b64_tr_b16 v[52:53], v10 offset:18440
    ds_read_b64_tr_b16 v[54:55], v10 offset:18952
    s_waitcnt lgkmcnt(8)
    v_mfma_f32_16x16x32_bf16 v[80:83], v[40:43], v[16:19], v[80:83]
    v_mfma_f32_16x16x32_bf16 v[84:87], v[40:43], v[20:23], v[84:87]
    ds_read_b64_tr_b16 v[56:57], v12 offset:18432
    ds_read_b64_tr_b16 v[58:59], v12 offset:18944
    s_waitcnt lgkmcnt(8)
    v_mfma_f32_16x16x32_bf16 v[88:91], v[44:47], v[16:19], v[88:91]
    v_mfma_f32_16x16x32_bf16 v[92:95], v[44:47], v[20:23], v[92:95]
    ds_read_b64_tr_b16 v[60:61], v12 offset:18440
    ds_read_b64_tr_b16 v[62:63], v12 offset:18952
    s_waitcnt lgkmcnt(0)
    s_barrier
    ds_read_b128 v[16:19], v11 offset:16384
    ds_read_b128 v[20:23], v11 offset:18432
    v_mfma_f32_16x16x32_bf16 v[64:67], v[48:51], v[24:27], v[64:67]
    v_mfma_f32_16x16x32_bf16 v[68:71], v[48:51], v[28:31], v[68:71]
    ds_read_b64_tr_b16 v[32:33], v10 offset:20480
    ds_read_b64_tr_b16 v[34:35], v10 offset:20992
    v_mfma_f32_16x16x32_bf16 v[72:75], v[52:55], v[24:27], v[72:75]
    v_mfma_f32_16x16x32_bf16 v[76:79], v[52:55], v[28:31], v[76:79]
    ds_read_b64_tr_b16 v[36:37], v10 offset:20488
    ds_read_b64_tr_b16 v[38:39], v10 offset:21000
    v_mfma_f32_16x16x32_bf16 v[80:83], v[56:59], v[24:27], v[80:83]
    v_mfma_f32_16x16x32_bf16 v[84:87], v[56:59], v[28:31], v[84:87]
    ds_read_b64_tr_b16 v[40:41], v12 offset:20480
    ds_read_b64_tr_b16 v[42:43], v12 offset:20992
    v_mfma_f32_16x16x32_bf16 v[88:91], v[60:63], v[24:27], v[88:91]
    v_mfma_f32_16x16x32_bf16 v[92:95], v[60:63], v[28:31], v[92:95]
    ds_read_b64_tr_b16 v[44:45], v12 offset:20488
    ds_read_b64_tr_b16 v[46:47], v12 offset:21000
    ds_read_b128 v[24:27], v11 offset:17408
    ds_read_b128 v[28:31], v11 offset:19456
    s_waitcnt lgkmcnt(8)
    v_mfma_f32_16x16x32_bf16 v[64:67], v[32:35], v[16:19], v[64:67]
    v_mfma_f32_16x16x32_bf16 v[68:71], v[32:35], v[20:23], v[68:71]
    ds_read_b64_tr_b16 v[48:49], v10 offset:22528
    ds_read_b64_tr_b16 v[50:51], v10 offset:23040
    s_waitcnt lgkmcnt(8)
    v_mfma_f32_16x16x32_bf16 v[72:75], v[36:39], v[16:19], v[72:75]
    v_mfma_f32_16x16x32_bf16 v[76:79], v[36:39], v[20:23], v[76:79]
    ds_read_b64_tr_b16 v[52:53], v10 offset:22536
    ds_read_b64_tr_b16 v[54:55], v10 offset:23048
    s_waitcnt lgkmcnt(8)
    v_mfma_f32_16x16x32_bf16 v[80:83], v[40:43], v[16:19], v[80:83]
    v_mfma_f32_16x16x32_bf16 v[84:87], v[40:43], v[20:23], v[84:87]
    ds_read_b64_tr_b16 v[56:57], v12 offset:22528
    ds_read_b64_tr_b16 v[58:59], v12 offset:23040
    s_waitcnt lgkmcnt(8)
    v_mfma_f32_16x16x32_bf16 v[88:91], v[44:47], v[16:19], v[88:91]
    v_mfma_f32_16x16x32_bf16 v[92:95], v[44:47], v[20:23], v[92:95]
    ds_read_b64_tr_b16 v[60:61], v12 offset:22536
    ds_read_b64_tr_b16 v[62:63], v12 offset:23048
    s_waitcnt lgkmcnt(0)
    s_barrier
    ds_read_b128 v[16:19], v6 offset:0
    ds_read_b128 v[20:23], v6 offset:2048
    v_mfma_f32_16x16x32_bf16 v[64:67], v[48:51], v[24:27], v[64:67]
    v_mfma_f32_16x16x32_bf16 v[68:71], v[48:51], v[28:31], v[68:71]
    ds_read_b64_tr_b16 v[32:33], v10 offset:24576
    ds_read_b64_tr_b16 v[34:35], v10 offset:25088
    v_mfma_f32_16x16x32_bf16 v[72:75], v[52:55], v[24:27], v[72:75]
    v_mfma_f32_16x16x32_bf16 v[76:79], v[52:55], v[28:31], v[76:79]
    ds_read_b64_tr_b16 v[36:37], v10 offset:24584
    ds_read_b64_tr_b16 v[38:39], v10 offset:25096
    v_mfma_f32_16x16x32_bf16 v[80:83], v[56:59], v[24:27], v[80:83]
    v_mfma_f32_16x16x32_bf16 v[84:87], v[56:59], v[28:31], v[84:87]
    ds_read_b64_tr_b16 v[40:41], v12 offset:24576
    ds_read_b64_tr_b16 v[42:43], v12 offset:25088
    v_mfma_f32_16x16x32_bf16 v[88:91], v[60:63], v[24:27], v[88:91]
    v_mfma_f32_16x16x32_bf16 v[92:95], v[60:63], v[28:31], v[92:95]
    ds_read_b64_tr_b16 v[44:45], v12 offset:24584
    ds_read_b64_tr_b16 v[46:47], v12 offset:25096
    ds_read_b128 v[24:27], v6 offset:1024
    ds_read_b128 v[28:31], v6 offset:3072
    s_waitcnt lgkmcnt(8)
    v_mfma_f32_16x16x32_bf16 v[64:67], v[32:35], v[16:19], v[64:67]
    v_mfma_f32_16x16x32_bf16 v[68:71], v[32:35], v[20:23], v[68:71]
    ds_read_b64_tr_b16 v[48:49], v10 offset:26624
    ds_read_b64_tr_b16 v[50:51], v10 offset:27136
    s_waitcnt lgkmcnt(8)
    v_mfma_f32_16x16x32_bf16 v[72:75], v[36:39], v[16:19], v[72:75]
    v_mfma_f32_16x16x32_bf16 v[76:79], v[36:39], v[20:23], v[76:79]
    ds_read_b64_tr_b16 v[52:53], v10 offset:26632
    ds_read_b64_tr_b16 v[54:55], v10 offset:27144
    s_waitcnt lgkmcnt(8)
    v_mfma_f32_16x16x32_bf16 v[80:83], v[40:43], v[16:19], v[80:83]
    v_mfma_f32_16x16x32_bf16 v[84:87], v[40:43], v[20:23], v[84:87]
    ds_read_b64_tr_b16 v[56:57], v12 offset:26624
    ds_read_b64_tr_b16 v[58:59], v12 offset:27136
    s_waitcnt lgkmcnt(8)
    v_mfma_f32_16x16x32_bf16 v[88:91], v[44:47], v[16:19], v[88:91]
    v_mfma_f32_16x16x32_bf16 v[92:95], v[44:47], v[20:23], v[92:95]
    ds_read_b64_tr_b16 v[60:61], v12 offset:26632
    ds_read_b64_tr_b16 v[62:63], v12 offset:27144
    s_waitcnt lgkmcnt(6)
    v_mfma_f32_16x16x32_bf16 v[64:67], v[48:51], v[24:27], v[64:67]
    v_mfma_f32_16x16x32_bf16 v[68:71], v[48:51], v[28:31], v[68:71]
    s_waitcnt lgkmcnt(4)
    v_mfma_f32_16x16x32_bf16 v[72:75], v[52:55], v[24:27], v[72:75]
    v_mfma_f32_16x16x32_bf16 v[76:79], v[52:55], v[28:31], v[76:79]
    s_waitcnt lgkmcnt(2)
    v_mfma_f32_16x16x32_bf16 v[80:83], v[56:59], v[24:27], v[80:83]
    v_mfma_f32_16x16x32_bf16 v[84:87], v[56:59], v[28:31], v[84:87]
    s_waitcnt lgkmcnt(0)
    v_mfma_f32_16x16x32_bf16 v[88:91], v[60:63], v[24:27], v[88:91]
    v_mfma_f32_16x16x32_bf16 v[92:95], v[60:63], v[28:31], v[92:95]
    v_cvt_pk_bf16_f32 v16, v64, v65
    v_cvt_pk_bf16_f32 v17, v66, v67
    v_cvt_pk_bf16_f32 v18, v72, v73
    v_cvt_pk_bf16_f32 v19, v74, v75
    buffer_store_dwordx4 v[16:19], v7, s[32:35], 0 offen offset:0 sc1
    v_cvt_pk_bf16_f32 v20, v68, v69
    v_cvt_pk_bf16_f32 v21, v70, v71
    v_cvt_pk_bf16_f32 v22, v76, v77
    v_cvt_pk_bf16_f32 v23, v78, v79
    buffer_store_dwordx4 v[20:23], v7, s[32:35], s48 offen offset:0 sc1
    v_cvt_pk_bf16_f32 v24, v80, v81
    v_cvt_pk_bf16_f32 v25, v82, v83
    v_cvt_pk_bf16_f32 v26, v88, v89
    v_cvt_pk_bf16_f32 v27, v90, v91
    buffer_store_dwordx4 v[24:27], v7, s[32:35], 0 offen offset:64 sc1
    v_cvt_pk_bf16_f32 v28, v84, v85
    v_cvt_pk_bf16_f32 v29, v86, v87
    v_cvt_pk_bf16_f32 v30, v92, v93
    v_cvt_pk_bf16_f32 v31, v94, v95
    buffer_store_dwordx4 v[28:31], v7, s[32:35], s48 offen offset:64 sc1
    s_endpgm
L_load_proj_kernel:
    s_mul_i32 s44, s43, 14336
    v_add_u32 v6, s44, v6
    s_lshl_b32 s58, s46, 12
    s_add_u32 s58, s58, 57472
    v_lshrrev_b32 v5, 3, v2
    s_lshl_b32 s49, s46, 4
    v_add_u32 v9, s49, v5
    v_mul_u32_u24 v9, 896, v9
    v_bfe_u32 v8, v5, 1, 1
    v_lshlrev_b32 v8, 2, v8
    v_and_b32 v12, 7, v2
    v_xor_b32 v8, v8, v12
    v_lshl_add_u32 v9, v8, 4, v9
    v_add_u32 v9, s47, v9
    s_lshr_b32 s45, s46, 1
    s_lshl_b32 s45, s45, 11
    s_and_b32 s49, s46, 1
    s_lshl_b32 s49, s49, 10
    s_add_u32 s45, s45, s49
    s_waitcnt lgkmcnt(0)
    s_cmp_eq_u32 s38, 0
    s_cselect_b32 s54, s8, s14
    s_cselect_b32 s55, s9, s15
    s_mov_b32 s28, s54
    s_and_b32 s29, s55, 0xffff
    s_mov_b32 s30, 401408
    s_mov_b32 s31, 0x00020000
    s_mul_i32 s56, s38, 1835008
    s_add_u32 s56, s56, 12582912
    s_add_u32 s52, s20, s56
    s_addc_u32 s53, s21, 0
    s_mov_b32 s24, s52
    s_and_b32 s25, s53, 0xffff
    s_mov_b32 s26, 1835008
    s_mov_b32 s27, 0x00020000
    s_add_u32 s57, s45, 0
    s_mov_b32 m0, s57
    s_mov_b32 s59, 0
    buffer_load_dwordx4 v9, s[28:31], s59 offen lds
    s_add_u32 s57, s45, 28680
    s_mov_b32 m0, s57
    s_mov_b32 s59, 7168
    buffer_load_dwordx4 v9, s[28:31], s59 offen lds
    s_add_u32 s57, s58, 0
    s_mov_b32 m0, s57
    s_mov_b32 s59, 0
    buffer_load_dwordx4 v6, s[24:27], s59 offen lds
    s_add_u32 s57, s58, 1024
    s_mov_b32 m0, s57
    s_mov_b32 s59, 1024
    buffer_load_dwordx4 v6, s[24:27], s59 offen lds
    s_add_u32 s57, s58, 2048
    s_mov_b32 m0, s57
    s_mov_b32 s59, 14336
    buffer_load_dwordx4 v6, s[24:27], s59 offen lds
    s_add_u32 s57, s58, 3072
    s_mov_b32 m0, s57
    s_mov_b32 s59, 15360
    buffer_load_dwordx4 v6, s[24:27], s59 offen lds
    s_add_u32 s57, s45, 4096
    s_mov_b32 m0, s57
    s_mov_b32 s59, 57344
    buffer_load_dwordx4 v9, s[28:31], s59 offen lds
    s_add_u32 s57, s45, 32776
    s_mov_b32 m0, s57
    s_mov_b32 s59, 64512
    buffer_load_dwordx4 v9, s[28:31], s59 offen lds
    s_add_u32 s57, s58, 16384
    s_mov_b32 m0, s57
    s_mov_b32 s59, 2048
    buffer_load_dwordx4 v6, s[24:27], s59 offen lds
    s_add_u32 s57, s58, 17408
    s_mov_b32 m0, s57
    s_mov_b32 s59, 3072
    buffer_load_dwordx4 v6, s[24:27], s59 offen lds
    s_add_u32 s57, s58, 18432
    s_mov_b32 m0, s57
    s_mov_b32 s59, 16384
    buffer_load_dwordx4 v6, s[24:27], s59 offen lds
    s_add_u32 s57, s58, 19456
    s_mov_b32 m0, s57
    s_mov_b32 s59, 17408
    buffer_load_dwordx4 v6, s[24:27], s59 offen lds
    s_add_u32 s57, s45, 8192
    s_mov_b32 m0, s57
    s_mov_b32 s59, 114688
    buffer_load_dwordx4 v9, s[28:31], s59 offen lds
    s_add_u32 s57, s45, 36872
    s_mov_b32 m0, s57
    s_mov_b32 s59, 121856
    buffer_load_dwordx4 v9, s[28:31], s59 offen lds
    s_add_u32 s57, s58, 32768
    s_mov_b32 m0, s57
    s_mov_b32 s59, 4096
    buffer_load_dwordx4 v6, s[24:27], s59 offen lds
    s_add_u32 s57, s58, 33792
    s_mov_b32 m0, s57
    s_mov_b32 s59, 5120
    buffer_load_dwordx4 v6, s[24:27], s59 offen lds
    s_add_u32 s57, s58, 34816
    s_mov_b32 m0, s57
    s_mov_b32 s59, 18432
    buffer_load_dwordx4 v6, s[24:27], s59 offen lds
    s_add_u32 s57, s58, 35840
    s_mov_b32 m0, s57
    s_mov_b32 s59, 19456
    buffer_load_dwordx4 v6, s[24:27], s59 offen lds
    s_waitcnt vmcnt(12)
    s_barrier
    s_add_u32 s57, s45, 12288
    s_mov_b32 m0, s57
    s_mov_b32 s59, 172032
    buffer_load_dwordx4 v9, s[28:31], s59 offen lds
    s_add_u32 s57, s45, 40968
    s_mov_b32 m0, s57
    s_mov_b32 s59, 179200
    buffer_load_dwordx4 v9, s[28:31], s59 offen lds
    s_add_u32 s57, s58, 49152
    s_mov_b32 m0, s57
    s_mov_b32 s59, 6144
    buffer_load_dwordx4 v6, s[24:27], s59 offen lds
    s_add_u32 s57, s58, 50176
    s_mov_b32 m0, s57
    s_mov_b32 s59, 7168
    buffer_load_dwordx4 v6, s[24:27], s59 offen lds
    s_add_u32 s57, s58, 51200
    s_mov_b32 m0, s57
    s_mov_b32 s59, 20480
    buffer_load_dwordx4 v6, s[24:27], s59 offen lds
    s_add_u32 s57, s58, 52224
    s_mov_b32 m0, s57
    s_mov_b32 s59, 21504
    buffer_load_dwordx4 v6, s[24:27], s59 offen lds
    s_waitcnt vmcnt(12)
    s_barrier
    s_add_u32 s57, s45, 16384
    s_mov_b32 m0, s57
    s_mov_b32 s59, 229376
    buffer_load_dwordx4 v9, s[28:31], s59 offen lds
    s_add_u32 s57, s45, 45064
    s_mov_b32 m0, s57
    s_mov_b32 s59, 236544
    buffer_load_dwordx4 v9, s[28:31], s59 offen lds
    s_add_u32 s57, s58, 65536
    s_mov_b32 m0, s57
    s_mov_b32 s59, 8192
    buffer_load_dwordx4 v6, s[24:27], s59 offen lds
    s_add_u32 s57, s58, 66560
    s_mov_b32 m0, s57
    s_mov_b32 s59, 9216
    buffer_load_dwordx4 v6, s[24:27], s59 offen lds
    s_add_u32 s57, s58, 67584
    s_mov_b32 m0, s57
    s_mov_b32 s59, 22528
    buffer_load_dwordx4 v6, s[24:27], s59 offen lds
    s_add_u32 s57, s58, 68608
    s_mov_b32 m0, s57
    s_mov_b32 s59, 23552
    buffer_load_dwordx4 v6, s[24:27], s59 offen lds
    s_waitcnt vmcnt(12)
    s_barrier
    s_add_u32 s57, s45, 20480
    s_mov_b32 m0, s57
    s_mov_b32 s59, 286720
    buffer_load_dwordx4 v9, s[28:31], s59 offen lds
    s_add_u32 s57, s45, 49160
    s_mov_b32 m0, s57
    s_mov_b32 s59, 293888
    buffer_load_dwordx4 v9, s[28:31], s59 offen lds
    s_add_u32 s57, s58, 81920
    s_mov_b32 m0, s57
    s_mov_b32 s59, 10240
    buffer_load_dwordx4 v6, s[24:27], s59 offen lds
    s_add_u32 s57, s58, 82944
    s_mov_b32 m0, s57
    s_mov_b32 s59, 11264
    buffer_load_dwordx4 v6, s[24:27], s59 offen lds
    s_add_u32 s57, s58, 83968
    s_mov_b32 m0, s57
    s_mov_b32 s59, 24576
    buffer_load_dwordx4 v6, s[24:27], s59 offen lds
    s_add_u32 s57, s58, 84992
    s_mov_b32 m0, s57
    s_mov_b32 s59, 25600
    buffer_load_dwordx4 v6, s[24:27], s59 offen lds
    s_waitcnt vmcnt(12)
    s_barrier
    s_add_u32 s57, s45, 24576
    s_mov_b32 m0, s57
    s_mov_b32 s59, 344064
    buffer_load_dwordx4 v9, s[28:31], s59 offen lds
    s_add_u32 s57, s45, 53256
    s_mov_b32 m0, s57
    s_mov_b32 s59, 351232
    buffer_load_dwordx4 v9, s[28:31], s59 offen lds
    s_add_u32 s57, s58, 0
    s_mov_b32 m0, s57
    s_mov_b32 s59, 12288
    buffer_load_dwordx4 v6, s[24:27], s59 offen lds
    s_add_u32 s57, s58, 1024
    s_mov_b32 m0, s57
    s_mov_b32 s59, 13312
    buffer_load_dwordx4 v6, s[24:27], s59 offen lds
    s_add_u32 s57, s58, 2048
    s_mov_b32 m0, s57
    s_mov_b32 s59, 26624
    buffer_load_dwordx4 v6, s[24:27], s59 offen lds
    s_add_u32 s57, s58, 3072
    s_mov_b32 m0, s57
    s_mov_b32 s59, 27648
    buffer_load_dwordx4 v6, s[24:27], s59 offen lds
    s_waitcnt vmcnt(12)
    s_barrier
    s_waitcnt vmcnt(6)
    s_barrier
    s_waitcnt vmcnt(0)
    s_barrier
L_end_proj_kernel:
    s_endpgm
.section .rodata,"a"
.p2align 6
.amdhsa_kernel qkv_kernel
  .amdhsa_next_free_vgpr 222
  .amdhsa_next_free_sgpr 64
  .amdhsa_accum_offset 224
  .amdhsa_group_segment_fixed_size 0
  .amdhsa_kernarg_size 72
  .amdhsa_user_sgpr_count 2
  .amdhsa_user_sgpr_kernarg_segment_ptr 1
  .amdhsa_system_sgpr_workgroup_id_x 1
.end_amdhsa_kernel
.p2align 6
.amdhsa_kernel attn_kernel
  .amdhsa_next_free_vgpr 256
  .amdhsa_next_free_sgpr 68
  .amdhsa_accum_offset 256
  .amdhsa_group_segment_fixed_size 0
  .amdhsa_kernarg_size 72
  .amdhsa_user_sgpr_count 2
  .amdhsa_user_sgpr_kernarg_segment_ptr 1
  .amdhsa_system_sgpr_workgroup_id_x 1
.end_amdhsa_kernel
.p2align 6
.amdhsa_kernel proj_kernel
  .amdhsa_next_free_vgpr 96
  .amdhsa_next_free_sgpr 60
  .amdhsa_accum_offset 96
  .amdhsa_group_segment_fixed_size 0
  .amdhsa_kernarg_size 72
  .amdhsa_user_sgpr_count 2
  .amdhsa_user_sgpr_kernarg_segment_ptr 1
  .amdhsa_system_sgpr_workgroup_id_x 1
.end_amdhsa_kernel
```
